```python
import torch

def _softmax(x, axis=-1):
    return torch.softmax(x, dim=axis)
def _gelu(x):
    return torch.nn.functional.gelu(x, approximate="tanh")
def _silu(x):
    return torch.nn.functional.silu(x)
def _sigmoid(x):
    return torch.sigmoid(x)
def _layernorm(x, axis=-1, eps=1e-5):
    m = x.mean(dim=axis, keepdim=True)
    v = x.var(dim=axis, keepdim=True, unbiased=False)
    return (x - m) / torch.sqrt(v + eps)
def _scatter_add(tgt, idx, src, axis=0):
    return tgt.clone().index_add_(axis, idx, src)
def _segment_sum(src, seg, n):
    out = torch.zeros((n,) + src.shape[1:], dtype=src.dtype)
    return out.index_add_(0, seg, src)
def _pad(x, pw):
    flat = tuple(v for pair in reversed(pw) for v in pair)
    return torch.nn.functional.pad(x, flat)

kernel_name = 'standalone__mha_block_cached__near_ridge'

def setup_inputs():

    _w = (lambda a: (lambda t: t.to(torch.bfloat16) if t.is_floating_point() else t)(torch.as_tensor(a)))
    B, Sq, D = 16, 32, 1024
    H, Sk, Dh = 32, 32, 128
    return {
        "x": _w((lambda *s: torch.randn(*s, dtype=torch.bfloat16) * 0.8)(B, Sq, D)),
        "k_cache": _w((lambda *s: torch.randn(*s, dtype=torch.bfloat16) * 0.8)(B, H, Sk, Dh)),
        "v_cache": _w((lambda *s: torch.randn(*s, dtype=torch.bfloat16) * 0.05)(B, H, Sk, Dh)),
        "wq": _w((lambda *s: torch.randn(*s, dtype=torch.bfloat16) * 0.8)(D, H * Dh) * (D ** -0.5)),
        "wo": _w((lambda *s: torch.randn(*s, dtype=torch.bfloat16) * 0.05)(H * Dh, D) * ((H * Dh) ** -0.5)),
    }

def reference(x, k_cache, v_cache, wq, wo):
    B, Sq, D = x.shape
    H, Dh = 32, 128
    q = (lambda x, *d: x.permute(*d))((x @ wq).reshape(B, Sq, H, Dh), 0, 2, 1, 3)
    scores = torch.einsum("bhqd,bhkd->bhqk", q, k_cache) * (Dh ** -0.5)
    p = _softmax(scores, axis=-1)
    o = torch.einsum("bhqk,bhkd->bhqd", p, v_cache)
    return (lambda x, *d: x.permute(*d))(o, 0, 2, 1, 3).reshape(B, Sq, H * Dh) @ wo
```

```asm
; @launch kernel=k1_kernel grid=(256,1,1) block=(256,1,1) lds=139264
; @launch kernel=k2_kernel grid=(256,1,1) block=(256,1,1) lds=131072
; @launch kernel=k3_kernel grid=(512,1,1) block=(256,1,1) lds=0
.amdgcn_target "amdgcn-amd-amdhsa--gfx950"
.text
.globl k1_kernel
.p2align 8
.type k1_kernel,@function
k1_kernel:
    s_cmp_ge_u32 s2, 256
    s_cbranch_scc1 k1_end
    s_load_dwordx8 s[4:11], s[0:1], 0
    s_load_dwordx2 s[12:13], s[0:1], 56
    v_lshrrev_b32 v2, 6, v0
    v_and_b32 v1, 63, v0
    s_nop 0
    v_readfirstlane_b32 s36, v2
    s_and_b32 s37, s2, 7
    s_lshl_b32 s37, s37, 2
    s_lshr_b32 s3, s2, 3
    s_and_b32 s38, s3, 3
    s_add_u32 s37, s37, s38
    s_lshr_b32 s38, s3, 2
    s_lshr_b32 s39, s36, 1
    s_and_b32 s40, s36, 1
    s_waitcnt lgkmcnt(0)
    s_mov_b32 s16, s4
    s_mov_b32 s17, s5
    s_mov_b32 s18, 1048576
    s_mov_b32 s19, 0x00020000
    s_mov_b32 s20, s6
    s_mov_b32 s21, s7
    s_mov_b32 s22, 4194304
    s_mov_b32 s23, 0x00020000
    s_mov_b32 s24, s8
    s_mov_b32 s25, s9
    s_mov_b32 s26, 4194304
    s_mov_b32 s27, 0x00020000
    s_mov_b32 s28, s10
    s_mov_b32 s29, s11
    s_mov_b32 s30, 8388608
    s_mov_b32 s31, 0x00020000
    s_mov_b32 s32, s12
    s_mov_b32 s33, s13
    s_mov_b32 s34, 4194304
    s_mov_b32 s35, 0x00020000
    v_lshrrev_b32 v3, 5, v1
    v_and_b32 v4, 31, v1
    s_lshl_b32 s43, s38, 1
    s_add_u32 s43, s43, s39
    s_lshl_b32 s44, s43, 5
    s_add_u32 s44, s44, s37
    s_lshl_b32 s44, s44, 13
    s_lshl_b32 s45, s40, 7
    s_add_u32 s45, s45, s44
    v_lshlrev_b32 v5, 8, v4
    v_lshl_add_u32 v5, v3, 3, v5
    v_add_u32 v5, s45, v5
    buffer_load_dwordx2 v[200:201], v5, s[20:23], 0 offen offset:0
    buffer_load_dwordx2 v[202:203], v5, s[20:23], 0 offen offset:16
    buffer_load_dwordx2 v[204:205], v5, s[20:23], 0 offen offset:32
    buffer_load_dwordx2 v[206:207], v5, s[20:23], 0 offen offset:48
    buffer_load_dwordx2 v[208:209], v5, s[20:23], 0 offen offset:64
    buffer_load_dwordx2 v[210:211], v5, s[20:23], 0 offen offset:80
    buffer_load_dwordx2 v[212:213], v5, s[20:23], 0 offen offset:96
    buffer_load_dwordx2 v[214:215], v5, s[20:23], 0 offen offset:112
    v_lshrrev_b32 v6, 4, v1
    v_and_b32 v7, 15, v1
    v_lshlrev_b32 v8, 2, v6
    v_xor_b32 v7, v7, v8
    v_lshlrev_b32 v9, 8, v6
    v_lshl_add_u32 v9, v7, 4, v9
    s_lshl_b32 s45, s40, 12
    s_add_u32 s45, s45, s44
    s_lshl_b32 s46, s36, 12
    s_add_u32 m0, s46, 122880
    s_add_u32 s47, s45, 0
    buffer_load_dwordx4 v9, s[24:27], s47 offen lds
    s_add_u32 m0, s46, 123904
    s_add_u32 s47, s45, 1024
    buffer_load_dwordx4 v9, s[24:27], s47 offen lds
    s_add_u32 m0, s46, 124928
    s_add_u32 s47, s45, 2048
    buffer_load_dwordx4 v9, s[24:27], s47 offen lds
    s_add_u32 m0, s46, 125952
    s_add_u32 s47, s45, 3072
    buffer_load_dwordx4 v9, s[24:27], s47 offen lds
    s_lshl_b32 s45, s36, 17
    s_lshl_b32 s47, s37, 8
    s_add_u32 s45, s45, s47
    v_lshlrev_b32 v10, 13, v6
    v_lshl_add_u32 v10, v7, 4, v10
    v_add_u32 v10, s45, v10
    v_add_u32 v11, 32768, v10
    v_add_u32 v12, 65536, v10
    v_add_u32 v13, 98304, v10
    v_lshrrev_b32 v16, 3, v1
    s_lshl_b32 s45, s36, 4
    v_add_u32 v16, s45, v16
    v_add_u32 v17, 0, v16
    v_lshrrev_b32 v18, 1, v17
    v_and_b32 v18, 7, v18
    v_and_b32 v19, 7, v1
    v_xor_b32 v18, v18, v19
    s_lshl_b32 s45, s38, 6
    v_add_u32 v17, s45, v17
    v_lshlrev_b32 v17, 11, v17
    v_lshl_add_u32 v14, v18, 4, v17
    v_add_u32 v17, 8, v16
    v_lshrrev_b32 v18, 1, v17
    v_and_b32 v18, 7, v18
    v_and_b32 v19, 7, v1
    v_xor_b32 v18, v18, v19
    s_lshl_b32 s45, s38, 6
    v_add_u32 v17, s45, v17
    v_lshlrev_b32 v17, 11, v17
    v_lshl_add_u32 v15, v18, 4, v17
    v_bfe_u32 v22, v1, 2, 2
    v_and_b32 v23, 3, v1
    v_bfe_u32 v24, v1, 4, 1
    v_lshlrev_b32 v24, 1, v24
    v_lshrrev_b32 v25, 1, v23
    v_add_u32 v24, v24, v25
    s_lshl_b32 s45, s40, 3
    v_add_u32 v24, s45, v24
    v_lshl_add_u32 v25, v3, 3, v22
    v_lshlrev_b32 v25, 8, v25
    v_and_b32 v26, 1, v23
    v_lshl_add_u32 v25, v26, 3, v25
    v_add_u32 v26, 0, v24
    v_lshlrev_b32 v27, 2, v22
    v_xor_b32 v26, v26, v27
    v_lshl_add_u32 v20, v26, 4, v25
    v_add_u32 v26, 4, v24
    v_lshlrev_b32 v27, 2, v22
    v_xor_b32 v26, v26, v27
    v_lshl_add_u32 v21, v26, 4, v25
    s_lshl_b32 s45, s39, 5
    v_add_u32 v26, s45, v4
    v_lshrrev_b32 v27, 1, v26
    v_and_b32 v27, 7, v27
    v_lshlrev_b32 v26, 7, v26
    v_add_u32 v26, 16384, v26
    v_add_u32 v32, 0, v3
    v_xor_b32 v32, v32, v27
    v_lshl_add_u32 v28, v32, 4, v26
    v_add_u32 v32, 2, v3
    v_xor_b32 v32, v32, v27
    v_lshl_add_u32 v29, v32, 4, v26
    v_add_u32 v32, 4, v3
    v_xor_b32 v32, v32, v27
    v_lshl_add_u32 v30, v32, 4, v26
    v_add_u32 v32, 6, v3
    v_xor_b32 v32, v32, v27
    v_lshl_add_u32 v31, v32, 4, v26
    v_mov_b32 v64, 0
    v_mov_b32 v65, 0
    v_mov_b32 v66, 0
    v_mov_b32 v67, 0
    v_mov_b32 v68, 0
    v_mov_b32 v69, 0
    v_mov_b32 v70, 0
    v_mov_b32 v71, 0
    v_mov_b32 v72, 0
    v_mov_b32 v73, 0
    v_mov_b32 v74, 0
    v_mov_b32 v75, 0
    v_mov_b32 v76, 0
    v_mov_b32 v77, 0
    v_mov_b32 v78, 0
    v_mov_b32 v79, 0
    v_mov_b32 v80, 0
    v_mov_b32 v81, 0
    v_mov_b32 v82, 0
    v_mov_b32 v83, 0
    v_mov_b32 v84, 0
    v_mov_b32 v85, 0
    v_mov_b32 v86, 0
    v_mov_b32 v87, 0
    v_mov_b32 v88, 0
    v_mov_b32 v89, 0
    v_mov_b32 v90, 0
    v_mov_b32 v91, 0
    v_mov_b32 v92, 0
    v_mov_b32 v93, 0
    v_mov_b32 v94, 0
    v_mov_b32 v95, 0
    s_lshl_b32 s50, s38, 1
    s_lshl_b32 s48, s36, 11
    s_lshl_b32 s49, s36, 12
    s_add_u32 m0, s48, 16384
    s_add_u32 s41, s50, 0
    s_and_b32 s41, s41, 15
    s_lshl_b32 s41, s41, 7
    buffer_load_dwordx4 v14, s[16:19], s41 offen lds
    s_add_u32 m0, s48, 17408
    s_add_u32 s41, s50, 0
    s_and_b32 s41, s41, 15
    s_lshl_b32 s41, s41, 7
    buffer_load_dwordx4 v15, s[16:19], s41 offen lds
    s_add_u32 m0, s49, 0
    s_add_u32 s41, s50, 0
    s_and_b32 s41, s41, 15
    s_lshl_b32 s41, s41, 19
    buffer_load_dwordx4 v10, s[28:31], s41 offen lds
    s_add_u32 m0, s49, 1024
    s_add_u32 s41, s50, 0
    s_and_b32 s41, s41, 15
    s_lshl_b32 s41, s41, 19
    buffer_load_dwordx4 v11, s[28:31], s41 offen lds
    s_add_u32 m0, s49, 2048
    s_add_u32 s41, s50, 0
    s_and_b32 s41, s41, 15
    s_lshl_b32 s41, s41, 19
    buffer_load_dwordx4 v12, s[28:31], s41 offen lds
    s_add_u32 m0, s49, 3072
    s_add_u32 s41, s50, 0
    s_and_b32 s41, s41, 15
    s_lshl_b32 s41, s41, 19
    buffer_load_dwordx4 v13, s[28:31], s41 offen lds
    s_add_u32 m0, s48, 40960
    s_add_u32 s41, s50, 1
    s_and_b32 s41, s41, 15
    s_lshl_b32 s41, s41, 7
    buffer_load_dwordx4 v14, s[16:19], s41 offen lds
    s_add_u32 m0, s48, 41984
    s_add_u32 s41, s50, 1
    s_and_b32 s41, s41, 15
    s_lshl_b32 s41, s41, 7
    buffer_load_dwordx4 v15, s[16:19], s41 offen lds
    s_add_u32 m0, s49, 24576
    s_add_u32 s41, s50, 1
    s_and_b32 s41, s41, 15
    s_lshl_b32 s41, s41, 19
    buffer_load_dwordx4 v10, s[28:31], s41 offen lds
    s_add_u32 m0, s49, 25600
    s_add_u32 s41, s50, 1
    s_and_b32 s41, s41, 15
    s_lshl_b32 s41, s41, 19
    buffer_load_dwordx4 v11, s[28:31], s41 offen lds
    s_add_u32 m0, s49, 26624
    s_add_u32 s41, s50, 1
    s_and_b32 s41, s41, 15
    s_lshl_b32 s41, s41, 19
    buffer_load_dwordx4 v12, s[28:31], s41 offen lds
    s_add_u32 m0, s49, 27648
    s_add_u32 s41, s50, 1
    s_and_b32 s41, s41, 15
    s_lshl_b32 s41, s41, 19
    buffer_load_dwordx4 v13, s[28:31], s41 offen lds
    s_add_u32 m0, s48, 65536
    s_add_u32 s41, s50, 2
    s_and_b32 s41, s41, 15
    s_lshl_b32 s41, s41, 7
    buffer_load_dwordx4 v14, s[16:19], s41 offen lds
    s_add_u32 m0, s48, 66560
    s_add_u32 s41, s50, 2
    s_and_b32 s41, s41, 15
    s_lshl_b32 s41, s41, 7
    buffer_load_dwordx4 v15, s[16:19], s41 offen lds
    s_add_u32 m0, s49, 49152
    s_add_u32 s41, s50, 2
    s_and_b32 s41, s41, 15
    s_lshl_b32 s41, s41, 19
    buffer_load_dwordx4 v10, s[28:31], s41 offen lds
    s_add_u32 m0, s49, 50176
    s_add_u32 s41, s50, 2
    s_and_b32 s41, s41, 15
    s_lshl_b32 s41, s41, 19
    buffer_load_dwordx4 v11, s[28:31], s41 offen lds
    s_add_u32 m0, s49, 51200
    s_add_u32 s41, s50, 2
    s_and_b32 s41, s41, 15
    s_lshl_b32 s41, s41, 19
    buffer_load_dwordx4 v12, s[28:31], s41 offen lds
    s_add_u32 m0, s49, 52224
    s_add_u32 s41, s50, 2
    s_and_b32 s41, s41, 15
    s_lshl_b32 s41, s41, 19
    buffer_load_dwordx4 v13, s[28:31], s41 offen lds
    s_add_u32 m0, s48, 90112
    s_add_u32 s41, s50, 3
    s_and_b32 s41, s41, 15
    s_lshl_b32 s41, s41, 7
    buffer_load_dwordx4 v14, s[16:19], s41 offen lds
    s_add_u32 m0, s48, 91136
    s_add_u32 s41, s50, 3
    s_and_b32 s41, s41, 15
    s_lshl_b32 s41, s41, 7
    buffer_load_dwordx4 v15, s[16:19], s41 offen lds
    s_add_u32 m0, s49, 73728
    s_add_u32 s41, s50, 3
    s_and_b32 s41, s41, 15
    s_lshl_b32 s41, s41, 19
    buffer_load_dwordx4 v10, s[28:31], s41 offen lds
    s_add_u32 m0, s49, 74752
    s_add_u32 s41, s50, 3
    s_and_b32 s41, s41, 15
    s_lshl_b32 s41, s41, 19
    buffer_load_dwordx4 v11, s[28:31], s41 offen lds
    s_add_u32 m0, s49, 75776
    s_add_u32 s41, s50, 3
    s_and_b32 s41, s41, 15
    s_lshl_b32 s41, s41, 19
    buffer_load_dwordx4 v12, s[28:31], s41 offen lds
    s_add_u32 m0, s49, 76800
    s_add_u32 s41, s50, 3
    s_and_b32 s41, s41, 15
    s_lshl_b32 s41, s41, 19
    buffer_load_dwordx4 v13, s[28:31], s41 offen lds
    s_waitcnt vmcnt(18)
    s_barrier
    s_add_u32 m0, s48, 114688
    s_add_u32 s41, s50, 4
    s_and_b32 s41, s41, 15
    s_lshl_b32 s41, s41, 7
    buffer_load_dwordx4 v14, s[16:19], s41 offen lds
    s_add_u32 m0, s48, 115712
    s_add_u32 s41, s50, 4
    s_and_b32 s41, s41, 15
    s_lshl_b32 s41, s41, 7
    buffer_load_dwordx4 v15, s[16:19], s41 offen lds
    s_add_u32 m0, s49, 98304
    s_add_u32 s41, s50, 4
    s_and_b32 s41, s41, 15
    s_lshl_b32 s41, s41, 19
    buffer_load_dwordx4 v10, s[28:31], s41 offen lds
    s_add_u32 m0, s49, 99328
    s_add_u32 s41, s50, 4
    s_and_b32 s41, s41, 15
    s_lshl_b32 s41, s41, 19
    buffer_load_dwordx4 v11, s[28:31], s41 offen lds
    s_add_u32 m0, s49, 100352
    s_add_u32 s41, s50, 4
    s_and_b32 s41, s41, 15
    s_lshl_b32 s41, s41, 19
    buffer_load_dwordx4 v12, s[28:31], s41 offen lds
    s_add_u32 m0, s49, 101376
    s_add_u32 s41, s50, 4
    s_and_b32 s41, s41, 15
    s_lshl_b32 s41, s41, 19
    buffer_load_dwordx4 v13, s[28:31], s41 offen lds
    v_add_u32 v40, 0, v20
    v_add_u32 v41, 0, v21
    v_add_u32 v42, 0, v28
    v_add_u32 v43, 0, v29
    v_add_u32 v44, 0, v30
    v_add_u32 v45, 0, v31
    ds_read_b128 v[100:103], v42
    ds_read_b64_tr_b16 v[104:105], v40 offset:0
    ds_read_b64_tr_b16 v[106:107], v40 offset:1024
    ds_read_b64_tr_b16 v[108:109], v41 offset:0
    ds_read_b64_tr_b16 v[110:111], v41 offset:1024
    ds_read_b128 v[112:115], v43
    ds_read_b64_tr_b16 v[116:117], v40 offset:4096
    ds_read_b64_tr_b16 v[118:119], v40 offset:5120
    ds_read_b64_tr_b16 v[120:121], v41 offset:4096
    ds_read_b64_tr_b16 v[122:123], v41 offset:5120
    ds_read_b128 v[124:127], v44
    ds_read_b64_tr_b16 v[128:129], v40 offset:8192
    ds_read_b64_tr_b16 v[130:131], v40 offset:9216
    ds_read_b64_tr_b16 v[132:133], v41 offset:8192
    ds_read_b64_tr_b16 v[134:135], v41 offset:9216
    ds_read_b128 v[136:139], v45
    ds_read_b64_tr_b16 v[140:141], v40 offset:12288
    ds_read_b64_tr_b16 v[142:143], v40 offset:13312
    ds_read_b64_tr_b16 v[144:145], v41 offset:12288
    ds_read_b64_tr_b16 v[146:147], v41 offset:13312
    s_waitcnt lgkmcnt(15)
    v_mfma_f32_32x32x16_bf16 v[64:79], v[104:107], v[100:103], v[64:79]
    v_mfma_f32_32x32x16_bf16 v[80:95], v[108:111], v[100:103], v[80:95]
    s_waitcnt lgkmcnt(10)
    v_mfma_f32_32x32x16_bf16 v[64:79], v[116:119], v[112:115], v[64:79]
    v_mfma_f32_32x32x16_bf16 v[80:95], v[120:123], v[112:115], v[80:95]
    s_waitcnt lgkmcnt(5)
    v_mfma_f32_32x32x16_bf16 v[64:79], v[128:131], v[124:127], v[64:79]
    v_mfma_f32_32x32x16_bf16 v[80:95], v[132:135], v[124:127], v[80:95]
    s_waitcnt lgkmcnt(0)
    v_mfma_f32_32x32x16_bf16 v[64:79], v[140:143], v[136:139], v[64:79]
    v_mfma_f32_32x32x16_bf16 v[80:95], v[144:147], v[136:139], v[80:95]
    s_waitcnt vmcnt(18)
    s_barrier
    s_add_u32 m0, s48, 16384
    s_add_u32 s41, s50, 5
    s_and_b32 s41, s41, 15
    s_lshl_b32 s41, s41, 7
    buffer_load_dwordx4 v14, s[16:19], s41 offen lds
    s_add_u32 m0, s48, 17408
    s_add_u32 s41, s50, 5
    s_and_b32 s41, s41, 15
    s_lshl_b32 s41, s41, 7
    buffer_load_dwordx4 v15, s[16:19], s41 offen lds
    s_add_u32 m0, s49, 0
    s_add_u32 s41, s50, 5
    s_and_b32 s41, s41, 15
    s_lshl_b32 s41, s41, 19
    buffer_load_dwordx4 v10, s[28:31], s41 offen lds
    s_add_u32 m0, s49, 1024
    s_add_u32 s41, s50, 5
    s_and_b32 s41, s41, 15
    s_lshl_b32 s41, s41, 19
    buffer_load_dwordx4 v11, s[28:31], s41 offen lds
    s_add_u32 m0, s49, 2048
    s_add_u32 s41, s50, 5
    s_and_b32 s41, s41, 15
    s_lshl_b32 s41, s41, 19
    buffer_load_dwordx4 v12, s[28:31], s41 offen lds
    s_add_u32 m0, s49, 3072
    s_add_u32 s41, s50, 5
    s_and_b32 s41, s41, 15
    s_lshl_b32 s41, s41, 19
    buffer_load_dwordx4 v13, s[28:31], s41 offen lds
    v_add_u32 v40, 24576, v20
    v_add_u32 v41, 24576, v21
    v_add_u32 v42, 24576, v28
    v_add_u32 v43, 24576, v29
    v_add_u32 v44, 24576, v30
    v_add_u32 v45, 24576, v31
    ds_read_b128 v[100:103], v42
    ds_read_b64_tr_b16 v[104:105], v40 offset:0
    ds_read_b64_tr_b16 v[106:107], v40 offset:1024
    ds_read_b64_tr_b16 v[108:109], v41 offset:0
    ds_read_b64_tr_b16 v[110:111], v41 offset:1024
    ds_read_b128 v[112:115], v43
    ds_read_b64_tr_b16 v[116:117], v40 offset:4096
    ds_read_b64_tr_b16 v[118:119], v40 offset:5120
    ds_read_b64_tr_b16 v[120:121], v41 offset:4096
    ds_read_b64_tr_b16 v[122:123], v41 offset:5120
    ds_read_b128 v[124:127], v44
    ds_read_b64_tr_b16 v[128:129], v40 offset:8192
    ds_read_b64_tr_b16 v[130:131], v40 offset:9216
    ds_read_b64_tr_b16 v[132:133], v41 offset:8192
    ds_read_b64_tr_b16 v[134:135], v41 offset:9216
    ds_read_b128 v[136:139], v45
    ds_read_b64_tr_b16 v[140:141], v40 offset:12288
    ds_read_b64_tr_b16 v[142:143], v40 offset:13312
    ds_read_b64_tr_b16 v[144:145], v41 offset:12288
    ds_read_b64_tr_b16 v[146:147], v41 offset:13312
    s_waitcnt lgkmcnt(15)
    v_mfma_f32_32x32x16_bf16 v[64:79], v[104:107], v[100:103], v[64:79]
    v_mfma_f32_32x32x16_bf16 v[80:95], v[108:111], v[100:103], v[80:95]
    s_waitcnt lgkmcnt(10)
    v_mfma_f32_32x32x16_bf16 v[64:79], v[116:119], v[112:115], v[64:79]
    v_mfma_f32_32x32x16_bf16 v[80:95], v[120:123], v[112:115], v[80:95]
    s_waitcnt lgkmcnt(5)
    v_mfma_f32_32x32x16_bf16 v[64:79], v[128:131], v[124:127], v[64:79]
    v_mfma_f32_32x32x16_bf16 v[80:95], v[132:135], v[124:127], v[80:95]
    s_waitcnt lgkmcnt(0)
    v_mfma_f32_32x32x16_bf16 v[64:79], v[140:143], v[136:139], v[64:79]
    v_mfma_f32_32x32x16_bf16 v[80:95], v[144:147], v[136:139], v[80:95]
    s_waitcnt vmcnt(18)
    s_barrier
    s_add_u32 m0, s48, 40960
    s_add_u32 s41, s50, 6
    s_and_b32 s41, s41, 15
    s_lshl_b32 s41, s41, 7
    buffer_load_dwordx4 v14, s[16:19], s41 offen lds
    s_add_u32 m0, s48, 41984
    s_add_u32 s41, s50, 6
    s_and_b32 s41, s41, 15
    s_lshl_b32 s41, s41, 7
    buffer_load_dwordx4 v15, s[16:19], s41 offen lds
    s_add_u32 m0, s49, 24576
    s_add_u32 s41, s50, 6
    s_and_b32 s41, s41, 15
    s_lshl_b32 s41, s41, 19
    buffer_load_dwordx4 v10, s[28:31], s41 offen lds
    s_add_u32 m0, s49, 25600
    s_add_u32 s41, s50, 6
    s_and_b32 s41, s41, 15
    s_lshl_b32 s41, s41, 19
    buffer_load_dwordx4 v11, s[28:31], s41 offen lds
    s_add_u32 m0, s49, 26624
    s_add_u32 s41, s50, 6
    s_and_b32 s41, s41, 15
    s_lshl_b32 s41, s41, 19
    buffer_load_dwordx4 v12, s[28:31], s41 offen lds
    s_add_u32 m0, s49, 27648
    s_add_u32 s41, s50, 6
    s_and_b32 s41, s41, 15
    s_lshl_b32 s41, s41, 19
    buffer_load_dwordx4 v13, s[28:31], s41 offen lds
    v_add_u32 v40, 49152, v20
    v_add_u32 v41, 49152, v21
    v_add_u32 v42, 49152, v28
    v_add_u32 v43, 49152, v29
    v_add_u32 v44, 49152, v30
    v_add_u32 v45, 49152, v31
    ds_read_b128 v[100:103], v42
    ds_read_b64_tr_b16 v[104:105], v40 offset:0
    ds_read_b64_tr_b16 v[106:107], v40 offset:1024
    ds_read_b64_tr_b16 v[108:109], v41 offset:0
    ds_read_b64_tr_b16 v[110:111], v41 offset:1024
    ds_read_b128 v[112:115], v43
    ds_read_b64_tr_b16 v[116:117], v40 offset:4096
    ds_read_b64_tr_b16 v[118:119], v40 offset:5120
    ds_read_b64_tr_b16 v[120:121], v41 offset:4096
    ds_read_b64_tr_b16 v[122:123], v41 offset:5120
    ds_read_b128 v[124:127], v44
    ds_read_b64_tr_b16 v[128:129], v40 offset:8192
    ds_read_b64_tr_b16 v[130:131], v40 offset:9216
    ds_read_b64_tr_b16 v[132:133], v41 offset:8192
    ds_read_b64_tr_b16 v[134:135], v41 offset:9216
    ds_read_b128 v[136:139], v45
    ds_read_b64_tr_b16 v[140:141], v40 offset:12288
    ds_read_b64_tr_b16 v[142:143], v40 offset:13312
    ds_read_b64_tr_b16 v[144:145], v41 offset:12288
    ds_read_b64_tr_b16 v[146:147], v41 offset:13312
    s_waitcnt lgkmcnt(15)
    v_mfma_f32_32x32x16_bf16 v[64:79], v[104:107], v[100:103], v[64:79]
    v_mfma_f32_32x32x16_bf16 v[80:95], v[108:111], v[100:103], v[80:95]
    s_waitcnt lgkmcnt(10)
    v_mfma_f32_32x32x16_bf16 v[64:79], v[116:119], v[112:115], v[64:79]
    v_mfma_f32_32x32x16_bf16 v[80:95], v[120:123], v[112:115], v[80:95]
    s_waitcnt lgkmcnt(5)
    v_mfma_f32_32x32x16_bf16 v[64:79], v[128:131], v[124:127], v[64:79]
    v_mfma_f32_32x32x16_bf16 v[80:95], v[132:135], v[124:127], v[80:95]
    s_waitcnt lgkmcnt(0)
    v_mfma_f32_32x32x16_bf16 v[64:79], v[140:143], v[136:139], v[64:79]
    v_mfma_f32_32x32x16_bf16 v[80:95], v[144:147], v[136:139], v[80:95]
    s_waitcnt vmcnt(18)
    s_barrier
    s_add_u32 m0, s48, 65536
    s_add_u32 s41, s50, 7
    s_and_b32 s41, s41, 15
    s_lshl_b32 s41, s41, 7
    buffer_load_dwordx4 v14, s[16:19], s41 offen lds
    s_add_u32 m0, s48, 66560
    s_add_u32 s41, s50, 7
    s_and_b32 s41, s41, 15
    s_lshl_b32 s41, s41, 7
    buffer_load_dwordx4 v15, s[16:19], s41 offen lds
    s_add_u32 m0, s49, 49152
    s_add_u32 s41, s50, 7
    s_and_b32 s41, s41, 15
    s_lshl_b32 s41, s41, 19
    buffer_load_dwordx4 v10, s[28:31], s41 offen lds
    s_add_u32 m0, s49, 50176
    s_add_u32 s41, s50, 7
    s_and_b32 s41, s41, 15
    s_lshl_b32 s41, s41, 19
    buffer_load_dwordx4 v11, s[28:31], s41 offen lds
    s_add_u32 m0, s49, 51200
    s_add_u32 s41, s50, 7
    s_and_b32 s41, s41, 15
    s_lshl_b32 s41, s41, 19
    buffer_load_dwordx4 v12, s[28:31], s41 offen lds
    s_add_u32 m0, s49, 52224
    s_add_u32 s41, s50, 7
    s_and_b32 s41, s41, 15
    s_lshl_b32 s41, s41, 19
    buffer_load_dwordx4 v13, s[28:31], s41 offen lds
    v_add_u32 v40, 73728, v20
    v_add_u32 v41, 73728, v21
    v_add_u32 v42, 73728, v28
    v_add_u32 v43, 73728, v29
    v_add_u32 v44, 73728, v30
    v_add_u32 v45, 73728, v31
    ds_read_b128 v[100:103], v42
    ds_read_b64_tr_b16 v[104:105], v40 offset:0
    ds_read_b64_tr_b16 v[106:107], v40 offset:1024
    ds_read_b64_tr_b16 v[108:109], v41 offset:0
    ds_read_b64_tr_b16 v[110:111], v41 offset:1024
    ds_read_b128 v[112:115], v43
    ds_read_b64_tr_b16 v[116:117], v40 offset:4096
    ds_read_b64_tr_b16 v[118:119], v40 offset:5120
    ds_read_b64_tr_b16 v[120:121], v41 offset:4096
    ds_read_b64_tr_b16 v[122:123], v41 offset:5120
    ds_read_b128 v[124:127], v44
    ds_read_b64_tr_b16 v[128:129], v40 offset:8192
    ds_read_b64_tr_b16 v[130:131], v40 offset:9216
    ds_read_b64_tr_b16 v[132:133], v41 offset:8192
    ds_read_b64_tr_b16 v[134:135], v41 offset:9216
    ds_read_b128 v[136:139], v45
    ds_read_b64_tr_b16 v[140:141], v40 offset:12288
    ds_read_b64_tr_b16 v[142:143], v40 offset:13312
    ds_read_b64_tr_b16 v[144:145], v41 offset:12288
    ds_read_b64_tr_b16 v[146:147], v41 offset:13312
    s_waitcnt lgkmcnt(15)
    v_mfma_f32_32x32x16_bf16 v[64:79], v[104:107], v[100:103], v[64:79]
    v_mfma_f32_32x32x16_bf16 v[80:95], v[108:111], v[100:103], v[80:95]
    s_waitcnt lgkmcnt(10)
    v_mfma_f32_32x32x16_bf16 v[64:79], v[116:119], v[112:115], v[64:79]
    v_mfma_f32_32x32x16_bf16 v[80:95], v[120:123], v[112:115], v[80:95]
    s_waitcnt lgkmcnt(5)
    v_mfma_f32_32x32x16_bf16 v[64:79], v[128:131], v[124:127], v[64:79]
    v_mfma_f32_32x32x16_bf16 v[80:95], v[132:135], v[124:127], v[80:95]
    s_waitcnt lgkmcnt(0)
    v_mfma_f32_32x32x16_bf16 v[64:79], v[140:143], v[136:139], v[64:79]
    v_mfma_f32_32x32x16_bf16 v[80:95], v[144:147], v[136:139], v[80:95]
    s_waitcnt vmcnt(18)
    s_barrier
    s_add_u32 m0, s48, 90112
    s_add_u32 s41, s50, 8
    s_and_b32 s41, s41, 15
    s_lshl_b32 s41, s41, 7
    buffer_load_dwordx4 v14, s[16:19], s41 offen lds
    s_add_u32 m0, s48, 91136
    s_add_u32 s41, s50, 8
    s_and_b32 s41, s41, 15
    s_lshl_b32 s41, s41, 7
    buffer_load_dwordx4 v15, s[16:19], s41 offen lds
    s_add_u32 m0, s49, 73728
    s_add_u32 s41, s50, 8
    s_and_b32 s41, s41, 15
    s_lshl_b32 s41, s41, 19
    buffer_load_dwordx4 v10, s[28:31], s41 offen lds
    s_add_u32 m0, s49, 74752
    s_add_u32 s41, s50, 8
    s_and_b32 s41, s41, 15
    s_lshl_b32 s41, s41, 19
    buffer_load_dwordx4 v11, s[28:31], s41 offen lds
    s_add_u32 m0, s49, 75776
    s_add_u32 s41, s50, 8
    s_and_b32 s41, s41, 15
    s_lshl_b32 s41, s41, 19
    buffer_load_dwordx4 v12, s[28:31], s41 offen lds
    s_add_u32 m0, s49, 76800
    s_add_u32 s41, s50, 8
    s_and_b32 s41, s41, 15
    s_lshl_b32 s41, s41, 19
    buffer_load_dwordx4 v13, s[28:31], s41 offen lds
    v_add_u32 v40, 98304, v20
    v_add_u32 v41, 98304, v21
    v_add_u32 v42, 98304, v28
    v_add_u32 v43, 98304, v29
    v_add_u32 v44, 98304, v30
    v_add_u32 v45, 98304, v31
    ds_read_b128 v[100:103], v42
    ds_read_b64_tr_b16 v[104:105], v40 offset:0
    ds_read_b64_tr_b16 v[106:107], v40 offset:1024
    ds_read_b64_tr_b16 v[108:109], v41 offset:0
    ds_read_b64_tr_b16 v[110:111], v41 offset:1024
    ds_read_b128 v[112:115], v43
    ds_read_b64_tr_b16 v[116:117], v40 offset:4096
    ds_read_b64_tr_b16 v[118:119], v40 offset:5120
    ds_read_b64_tr_b16 v[120:121], v41 offset:4096
    ds_read_b64_tr_b16 v[122:123], v41 offset:5120
    ds_read_b128 v[124:127], v44
    ds_read_b64_tr_b16 v[128:129], v40 offset:8192
    ds_read_b64_tr_b16 v[130:131], v40 offset:9216
    ds_read_b64_tr_b16 v[132:133], v41 offset:8192
    ds_read_b64_tr_b16 v[134:135], v41 offset:9216
    ds_read_b128 v[136:139], v45
    ds_read_b64_tr_b16 v[140:141], v40 offset:12288
    ds_read_b64_tr_b16 v[142:143], v40 offset:13312
    ds_read_b64_tr_b16 v[144:145], v41 offset:12288
    ds_read_b64_tr_b16 v[146:147], v41 offset:13312
    s_waitcnt lgkmcnt(15)
    v_mfma_f32_32x32x16_bf16 v[64:79], v[104:107], v[100:103], v[64:79]
    v_mfma_f32_32x32x16_bf16 v[80:95], v[108:111], v[100:103], v[80:95]
    s_waitcnt lgkmcnt(10)
    v_mfma_f32_32x32x16_bf16 v[64:79], v[116:119], v[112:115], v[64:79]
    v_mfma_f32_32x32x16_bf16 v[80:95], v[120:123], v[112:115], v[80:95]
    s_waitcnt lgkmcnt(5)
    v_mfma_f32_32x32x16_bf16 v[64:79], v[128:131], v[124:127], v[64:79]
    v_mfma_f32_32x32x16_bf16 v[80:95], v[132:135], v[124:127], v[80:95]
    s_waitcnt lgkmcnt(0)
    v_mfma_f32_32x32x16_bf16 v[64:79], v[140:143], v[136:139], v[64:79]
    v_mfma_f32_32x32x16_bf16 v[80:95], v[144:147], v[136:139], v[80:95]
    s_waitcnt vmcnt(18)
    s_barrier
    s_add_u32 m0, s48, 114688
    s_add_u32 s41, s50, 9
    s_and_b32 s41, s41, 15
    s_lshl_b32 s41, s41, 7
    buffer_load_dwordx4 v14, s[16:19], s41 offen lds
    s_add_u32 m0, s48, 115712
    s_add_u32 s41, s50, 9
    s_and_b32 s41, s41, 15
    s_lshl_b32 s41, s41, 7
    buffer_load_dwordx4 v15, s[16:19], s41 offen lds
    s_add_u32 m0, s49, 98304
    s_add_u32 s41, s50, 9
    s_and_b32 s41, s41, 15
    s_lshl_b32 s41, s41, 19
    buffer_load_dwordx4 v10, s[28:31], s41 offen lds
    s_add_u32 m0, s49, 99328
    s_add_u32 s41, s50, 9
    s_and_b32 s41, s41, 15
    s_lshl_b32 s41, s41, 19
    buffer_load_dwordx4 v11, s[28:31], s41 offen lds
    s_add_u32 m0, s49, 100352
    s_add_u32 s41, s50, 9
    s_and_b32 s41, s41, 15
    s_lshl_b32 s41, s41, 19
    buffer_load_dwordx4 v12, s[28:31], s41 offen lds
    s_add_u32 m0, s49, 101376
    s_add_u32 s41, s50, 9
    s_and_b32 s41, s41, 15
    s_lshl_b32 s41, s41, 19
    buffer_load_dwordx4 v13, s[28:31], s41 offen lds
    v_add_u32 v40, 0, v20
    v_add_u32 v41, 0, v21
    v_add_u32 v42, 0, v28
    v_add_u32 v43, 0, v29
    v_add_u32 v44, 0, v30
    v_add_u32 v45, 0, v31
    ds_read_b128 v[100:103], v42
    ds_read_b64_tr_b16 v[104:105], v40 offset:0
    ds_read_b64_tr_b16 v[106:107], v40 offset:1024
    ds_read_b64_tr_b16 v[108:109], v41 offset:0
    ds_read_b64_tr_b16 v[110:111], v41 offset:1024
    ds_read_b128 v[112:115], v43
    ds_read_b64_tr_b16 v[116:117], v40 offset:4096
    ds_read_b64_tr_b16 v[118:119], v40 offset:5120
    ds_read_b64_tr_b16 v[120:121], v41 offset:4096
    ds_read_b64_tr_b16 v[122:123], v41 offset:5120
    ds_read_b128 v[124:127], v44
    ds_read_b64_tr_b16 v[128:129], v40 offset:8192
    ds_read_b64_tr_b16 v[130:131], v40 offset:9216
    ds_read_b64_tr_b16 v[132:133], v41 offset:8192
    ds_read_b64_tr_b16 v[134:135], v41 offset:9216
    ds_read_b128 v[136:139], v45
    ds_read_b64_tr_b16 v[140:141], v40 offset:12288
    ds_read_b64_tr_b16 v[142:143], v40 offset:13312
    ds_read_b64_tr_b16 v[144:145], v41 offset:12288
    ds_read_b64_tr_b16 v[146:147], v41 offset:13312
    s_waitcnt lgkmcnt(15)
    v_mfma_f32_32x32x16_bf16 v[64:79], v[104:107], v[100:103], v[64:79]
    v_mfma_f32_32x32x16_bf16 v[80:95], v[108:111], v[100:103], v[80:95]
    s_waitcnt lgkmcnt(10)
    v_mfma_f32_32x32x16_bf16 v[64:79], v[116:119], v[112:115], v[64:79]
    v_mfma_f32_32x32x16_bf16 v[80:95], v[120:123], v[112:115], v[80:95]
    s_waitcnt lgkmcnt(5)
    v_mfma_f32_32x32x16_bf16 v[64:79], v[128:131], v[124:127], v[64:79]
    v_mfma_f32_32x32x16_bf16 v[80:95], v[132:135], v[124:127], v[80:95]
    s_waitcnt lgkmcnt(0)
    v_mfma_f32_32x32x16_bf16 v[64:79], v[140:143], v[136:139], v[64:79]
    v_mfma_f32_32x32x16_bf16 v[80:95], v[144:147], v[136:139], v[80:95]
    s_waitcnt vmcnt(18)
    s_barrier
    s_add_u32 m0, s48, 16384
    s_add_u32 s41, s50, 10
    s_and_b32 s41, s41, 15
    s_lshl_b32 s41, s41, 7
    buffer_load_dwordx4 v14, s[16:19], s41 offen lds
    s_add_u32 m0, s48, 17408
    s_add_u32 s41, s50, 10
    s_and_b32 s41, s41, 15
    s_lshl_b32 s41, s41, 7
    buffer_load_dwordx4 v15, s[16:19], s41 offen lds
    s_add_u32 m0, s49, 0
    s_add_u32 s41, s50, 10
    s_and_b32 s41, s41, 15
    s_lshl_b32 s41, s41, 19
    buffer_load_dwordx4 v10, s[28:31], s41 offen lds
    s_add_u32 m0, s49, 1024
    s_add_u32 s41, s50, 10
    s_and_b32 s41, s41, 15
    s_lshl_b32 s41, s41, 19
    buffer_load_dwordx4 v11, s[28:31], s41 offen lds
    s_add_u32 m0, s49, 2048
    s_add_u32 s41, s50, 10
    s_and_b32 s41, s41, 15
    s_lshl_b32 s41, s41, 19
    buffer_load_dwordx4 v12, s[28:31], s41 offen lds
    s_add_u32 m0, s49, 3072
    s_add_u32 s41, s50, 10
    s_and_b32 s41, s41, 15
    s_lshl_b32 s41, s41, 19
    buffer_load_dwordx4 v13, s[28:31], s41 offen lds
    v_add_u32 v40, 24576, v20
    v_add_u32 v41, 24576, v21
    v_add_u32 v42, 24576, v28
    v_add_u32 v43, 24576, v29
    v_add_u32 v44, 24576, v30
    v_add_u32 v45, 24576, v31
    ds_read_b128 v[100:103], v42
    ds_read_b64_tr_b16 v[104:105], v40 offset:0
    ds_read_b64_tr_b16 v[106:107], v40 offset:1024
    ds_read_b64_tr_b16 v[108:109], v41 offset:0
    ds_read_b64_tr_b16 v[110:111], v41 offset:1024
    ds_read_b128 v[112:115], v43
    ds_read_b64_tr_b16 v[116:117], v40 offset:4096
    ds_read_b64_tr_b16 v[118:119], v40 offset:5120
    ds_read_b64_tr_b16 v[120:121], v41 offset:4096
    ds_read_b64_tr_b16 v[122:123], v41 offset:5120
    ds_read_b128 v[124:127], v44
    ds_read_b64_tr_b16 v[128:129], v40 offset:8192
    ds_read_b64_tr_b16 v[130:131], v40 offset:9216
    ds_read_b64_tr_b16 v[132:133], v41 offset:8192
    ds_read_b64_tr_b16 v[134:135], v41 offset:9216
    ds_read_b128 v[136:139], v45
    ds_read_b64_tr_b16 v[140:141], v40 offset:12288
    ds_read_b64_tr_b16 v[142:143], v40 offset:13312
    ds_read_b64_tr_b16 v[144:145], v41 offset:12288
    ds_read_b64_tr_b16 v[146:147], v41 offset:13312
    s_waitcnt lgkmcnt(15)
    v_mfma_f32_32x32x16_bf16 v[64:79], v[104:107], v[100:103], v[64:79]
    v_mfma_f32_32x32x16_bf16 v[80:95], v[108:111], v[100:103], v[80:95]
    s_waitcnt lgkmcnt(10)
    v_mfma_f32_32x32x16_bf16 v[64:79], v[116:119], v[112:115], v[64:79]
    v_mfma_f32_32x32x16_bf16 v[80:95], v[120:123], v[112:115], v[80:95]
    s_waitcnt lgkmcnt(5)
    v_mfma_f32_32x32x16_bf16 v[64:79], v[128:131], v[124:127], v[64:79]
    v_mfma_f32_32x32x16_bf16 v[80:95], v[132:135], v[124:127], v[80:95]
    s_waitcnt lgkmcnt(0)
    v_mfma_f32_32x32x16_bf16 v[64:79], v[140:143], v[136:139], v[64:79]
    v_mfma_f32_32x32x16_bf16 v[80:95], v[144:147], v[136:139], v[80:95]
    s_waitcnt vmcnt(18)
    s_barrier
    s_add_u32 m0, s48, 40960
    s_add_u32 s41, s50, 11
    s_and_b32 s41, s41, 15
    s_lshl_b32 s41, s41, 7
    buffer_load_dwordx4 v14, s[16:19], s41 offen lds
    s_add_u32 m0, s48, 41984
    s_add_u32 s41, s50, 11
    s_and_b32 s41, s41, 15
    s_lshl_b32 s41, s41, 7
    buffer_load_dwordx4 v15, s[16:19], s41 offen lds
    s_add_u32 m0, s49, 24576
    s_add_u32 s41, s50, 11
    s_and_b32 s41, s41, 15
    s_lshl_b32 s41, s41, 19
    buffer_load_dwordx4 v10, s[28:31], s41 offen lds
    s_add_u32 m0, s49, 25600
    s_add_u32 s41, s50, 11
    s_and_b32 s41, s41, 15
    s_lshl_b32 s41, s41, 19
    buffer_load_dwordx4 v11, s[28:31], s41 offen lds
    s_add_u32 m0, s49, 26624
    s_add_u32 s41, s50, 11
    s_and_b32 s41, s41, 15
    s_lshl_b32 s41, s41, 19
    buffer_load_dwordx4 v12, s[28:31], s41 offen lds
    s_add_u32 m0, s49, 27648
    s_add_u32 s41, s50, 11
    s_and_b32 s41, s41, 15
    s_lshl_b32 s41, s41, 19
    buffer_load_dwordx4 v13, s[28:31], s41 offen lds
    v_add_u32 v40, 49152, v20
    v_add_u32 v41, 49152, v21
    v_add_u32 v42, 49152, v28
    v_add_u32 v43, 49152, v29
    v_add_u32 v44, 49152, v30
    v_add_u32 v45, 49152, v31
    ds_read_b128 v[100:103], v42
    ds_read_b64_tr_b16 v[104:105], v40 offset:0
    ds_read_b64_tr_b16 v[106:107], v40 offset:1024
    ds_read_b64_tr_b16 v[108:109], v41 offset:0
    ds_read_b64_tr_b16 v[110:111], v41 offset:1024
    ds_read_b128 v[112:115], v43
    ds_read_b64_tr_b16 v[116:117], v40 offset:4096
    ds_read_b64_tr_b16 v[118:119], v40 offset:5120
    ds_read_b64_tr_b16 v[120:121], v41 offset:4096
    ds_read_b64_tr_b16 v[122:123], v41 offset:5120
    ds_read_b128 v[124:127], v44
    ds_read_b64_tr_b16 v[128:129], v40 offset:8192
    ds_read_b64_tr_b16 v[130:131], v40 offset:9216
    ds_read_b64_tr_b16 v[132:133], v41 offset:8192
    ds_read_b64_tr_b16 v[134:135], v41 offset:9216
    ds_read_b128 v[136:139], v45
    ds_read_b64_tr_b16 v[140:141], v40 offset:12288
    ds_read_b64_tr_b16 v[142:143], v40 offset:13312
    ds_read_b64_tr_b16 v[144:145], v41 offset:12288
    ds_read_b64_tr_b16 v[146:147], v41 offset:13312
    s_waitcnt lgkmcnt(15)
    v_mfma_f32_32x32x16_bf16 v[64:79], v[104:107], v[100:103], v[64:79]
    v_mfma_f32_32x32x16_bf16 v[80:95], v[108:111], v[100:103], v[80:95]
    s_waitcnt lgkmcnt(10)
    v_mfma_f32_32x32x16_bf16 v[64:79], v[116:119], v[112:115], v[64:79]
    v_mfma_f32_32x32x16_bf16 v[80:95], v[120:123], v[112:115], v[80:95]
    s_waitcnt lgkmcnt(5)
    v_mfma_f32_32x32x16_bf16 v[64:79], v[128:131], v[124:127], v[64:79]
    v_mfma_f32_32x32x16_bf16 v[80:95], v[132:135], v[124:127], v[80:95]
    s_waitcnt lgkmcnt(0)
    v_mfma_f32_32x32x16_bf16 v[64:79], v[140:143], v[136:139], v[64:79]
    v_mfma_f32_32x32x16_bf16 v[80:95], v[144:147], v[136:139], v[80:95]
    s_waitcnt vmcnt(18)
    s_barrier
    s_add_u32 m0, s48, 65536
    s_add_u32 s41, s50, 12
    s_and_b32 s41, s41, 15
    s_lshl_b32 s41, s41, 7
    buffer_load_dwordx4 v14, s[16:19], s41 offen lds
    s_add_u32 m0, s48, 66560
    s_add_u32 s41, s50, 12
    s_and_b32 s41, s41, 15
    s_lshl_b32 s41, s41, 7
    buffer_load_dwordx4 v15, s[16:19], s41 offen lds
    s_add_u32 m0, s49, 49152
    s_add_u32 s41, s50, 12
    s_and_b32 s41, s41, 15
    s_lshl_b32 s41, s41, 19
    buffer_load_dwordx4 v10, s[28:31], s41 offen lds
    s_add_u32 m0, s49, 50176
    s_add_u32 s41, s50, 12
    s_and_b32 s41, s41, 15
    s_lshl_b32 s41, s41, 19
    buffer_load_dwordx4 v11, s[28:31], s41 offen lds
    s_add_u32 m0, s49, 51200
    s_add_u32 s41, s50, 12
    s_and_b32 s41, s41, 15
    s_lshl_b32 s41, s41, 19
    buffer_load_dwordx4 v12, s[28:31], s41 offen lds
    s_add_u32 m0, s49, 52224
    s_add_u32 s41, s50, 12
    s_and_b32 s41, s41, 15
    s_lshl_b32 s41, s41, 19
    buffer_load_dwordx4 v13, s[28:31], s41 offen lds
    v_add_u32 v40, 73728, v20
    v_add_u32 v41, 73728, v21
    v_add_u32 v42, 73728, v28
    v_add_u32 v43, 73728, v29
    v_add_u32 v44, 73728, v30
    v_add_u32 v45, 73728, v31
    ds_read_b128 v[100:103], v42
    ds_read_b64_tr_b16 v[104:105], v40 offset:0
    ds_read_b64_tr_b16 v[106:107], v40 offset:1024
    ds_read_b64_tr_b16 v[108:109], v41 offset:0
    ds_read_b64_tr_b16 v[110:111], v41 offset:1024
    ds_read_b128 v[112:115], v43
    ds_read_b64_tr_b16 v[116:117], v40 offset:4096
    ds_read_b64_tr_b16 v[118:119], v40 offset:5120
    ds_read_b64_tr_b16 v[120:121], v41 offset:4096
    ds_read_b64_tr_b16 v[122:123], v41 offset:5120
    ds_read_b128 v[124:127], v44
    ds_read_b64_tr_b16 v[128:129], v40 offset:8192
    ds_read_b64_tr_b16 v[130:131], v40 offset:9216
    ds_read_b64_tr_b16 v[132:133], v41 offset:8192
    ds_read_b64_tr_b16 v[134:135], v41 offset:9216
    ds_read_b128 v[136:139], v45
    ds_read_b64_tr_b16 v[140:141], v40 offset:12288
    ds_read_b64_tr_b16 v[142:143], v40 offset:13312
    ds_read_b64_tr_b16 v[144:145], v41 offset:12288
    ds_read_b64_tr_b16 v[146:147], v41 offset:13312
    s_waitcnt lgkmcnt(15)
    v_mfma_f32_32x32x16_bf16 v[64:79], v[104:107], v[100:103], v[64:79]
    v_mfma_f32_32x32x16_bf16 v[80:95], v[108:111], v[100:103], v[80:95]
    s_waitcnt lgkmcnt(10)
    v_mfma_f32_32x32x16_bf16 v[64:79], v[116:119], v[112:115], v[64:79]
    v_mfma_f32_32x32x16_bf16 v[80:95], v[120:123], v[112:115], v[80:95]
    s_waitcnt lgkmcnt(5)
    v_mfma_f32_32x32x16_bf16 v[64:79], v[128:131], v[124:127], v[64:79]
    v_mfma_f32_32x32x16_bf16 v[80:95], v[132:135], v[124:127], v[80:95]
    s_waitcnt lgkmcnt(0)
    v_mfma_f32_32x32x16_bf16 v[64:79], v[140:143], v[136:139], v[64:79]
    v_mfma_f32_32x32x16_bf16 v[80:95], v[144:147], v[136:139], v[80:95]
    s_waitcnt vmcnt(18)
    s_barrier
    s_add_u32 m0, s48, 90112
    s_add_u32 s41, s50, 13
    s_and_b32 s41, s41, 15
    s_lshl_b32 s41, s41, 7
    buffer_load_dwordx4 v14, s[16:19], s41 offen lds
    s_add_u32 m0, s48, 91136
    s_add_u32 s41, s50, 13
    s_and_b32 s41, s41, 15
    s_lshl_b32 s41, s41, 7
    buffer_load_dwordx4 v15, s[16:19], s41 offen lds
    s_add_u32 m0, s49, 73728
    s_add_u32 s41, s50, 13
    s_and_b32 s41, s41, 15
    s_lshl_b32 s41, s41, 19
    buffer_load_dwordx4 v10, s[28:31], s41 offen lds
    s_add_u32 m0, s49, 74752
    s_add_u32 s41, s50, 13
    s_and_b32 s41, s41, 15
    s_lshl_b32 s41, s41, 19
    buffer_load_dwordx4 v11, s[28:31], s41 offen lds
    s_add_u32 m0, s49, 75776
    s_add_u32 s41, s50, 13
    s_and_b32 s41, s41, 15
    s_lshl_b32 s41, s41, 19
    buffer_load_dwordx4 v12, s[28:31], s41 offen lds
    s_add_u32 m0, s49, 76800
    s_add_u32 s41, s50, 13
    s_and_b32 s41, s41, 15
    s_lshl_b32 s41, s41, 19
    buffer_load_dwordx4 v13, s[28:31], s41 offen lds
    v_add_u32 v40, 98304, v20
    v_add_u32 v41, 98304, v21
    v_add_u32 v42, 98304, v28
    v_add_u32 v43, 98304, v29
    v_add_u32 v44, 98304, v30
    v_add_u32 v45, 98304, v31
    ds_read_b128 v[100:103], v42
    ds_read_b64_tr_b16 v[104:105], v40 offset:0
    ds_read_b64_tr_b16 v[106:107], v40 offset:1024
    ds_read_b64_tr_b16 v[108:109], v41 offset:0
    ds_read_b64_tr_b16 v[110:111], v41 offset:1024
    ds_read_b128 v[112:115], v43
    ds_read_b64_tr_b16 v[116:117], v40 offset:4096
    ds_read_b64_tr_b16 v[118:119], v40 offset:5120
    ds_read_b64_tr_b16 v[120:121], v41 offset:4096
    ds_read_b64_tr_b16 v[122:123], v41 offset:5120
    ds_read_b128 v[124:127], v44
    ds_read_b64_tr_b16 v[128:129], v40 offset:8192
    ds_read_b64_tr_b16 v[130:131], v40 offset:9216
    ds_read_b64_tr_b16 v[132:133], v41 offset:8192
    ds_read_b64_tr_b16 v[134:135], v41 offset:9216
    ds_read_b128 v[136:139], v45
    ds_read_b64_tr_b16 v[140:141], v40 offset:12288
    ds_read_b64_tr_b16 v[142:143], v40 offset:13312
    ds_read_b64_tr_b16 v[144:145], v41 offset:12288
    ds_read_b64_tr_b16 v[146:147], v41 offset:13312
    s_waitcnt lgkmcnt(15)
    v_mfma_f32_32x32x16_bf16 v[64:79], v[104:107], v[100:103], v[64:79]
    v_mfma_f32_32x32x16_bf16 v[80:95], v[108:111], v[100:103], v[80:95]
    s_waitcnt lgkmcnt(10)
    v_mfma_f32_32x32x16_bf16 v[64:79], v[116:119], v[112:115], v[64:79]
    v_mfma_f32_32x32x16_bf16 v[80:95], v[120:123], v[112:115], v[80:95]
    s_waitcnt lgkmcnt(5)
    v_mfma_f32_32x32x16_bf16 v[64:79], v[128:131], v[124:127], v[64:79]
    v_mfma_f32_32x32x16_bf16 v[80:95], v[132:135], v[124:127], v[80:95]
    s_waitcnt lgkmcnt(0)
    v_mfma_f32_32x32x16_bf16 v[64:79], v[140:143], v[136:139], v[64:79]
    v_mfma_f32_32x32x16_bf16 v[80:95], v[144:147], v[136:139], v[80:95]
    s_waitcnt vmcnt(18)
    s_barrier
    s_add_u32 m0, s48, 114688
    s_add_u32 s41, s50, 14
    s_and_b32 s41, s41, 15
    s_lshl_b32 s41, s41, 7
    buffer_load_dwordx4 v14, s[16:19], s41 offen lds
    s_add_u32 m0, s48, 115712
    s_add_u32 s41, s50, 14
    s_and_b32 s41, s41, 15
    s_lshl_b32 s41, s41, 7
    buffer_load_dwordx4 v15, s[16:19], s41 offen lds
    s_add_u32 m0, s49, 98304
    s_add_u32 s41, s50, 14
    s_and_b32 s41, s41, 15
    s_lshl_b32 s41, s41, 19
    buffer_load_dwordx4 v10, s[28:31], s41 offen lds
    s_add_u32 m0, s49, 99328
    s_add_u32 s41, s50, 14
    s_and_b32 s41, s41, 15
    s_lshl_b32 s41, s41, 19
    buffer_load_dwordx4 v11, s[28:31], s41 offen lds
    s_add_u32 m0, s49, 100352
    s_add_u32 s41, s50, 14
    s_and_b32 s41, s41, 15
    s_lshl_b32 s41, s41, 19
    buffer_load_dwordx4 v12, s[28:31], s41 offen lds
    s_add_u32 m0, s49, 101376
    s_add_u32 s41, s50, 14
    s_and_b32 s41, s41, 15
    s_lshl_b32 s41, s41, 19
    buffer_load_dwordx4 v13, s[28:31], s41 offen lds
    v_add_u32 v40, 0, v20
    v_add_u32 v41, 0, v21
    v_add_u32 v42, 0, v28
    v_add_u32 v43, 0, v29
    v_add_u32 v44, 0, v30
    v_add_u32 v45, 0, v31
    ds_read_b128 v[100:103], v42
    ds_read_b64_tr_b16 v[104:105], v40 offset:0
    ds_read_b64_tr_b16 v[106:107], v40 offset:1024
    ds_read_b64_tr_b16 v[108:109], v41 offset:0
    ds_read_b64_tr_b16 v[110:111], v41 offset:1024
    ds_read_b128 v[112:115], v43
    ds_read_b64_tr_b16 v[116:117], v40 offset:4096
    ds_read_b64_tr_b16 v[118:119], v40 offset:5120
    ds_read_b64_tr_b16 v[120:121], v41 offset:4096
    ds_read_b64_tr_b16 v[122:123], v41 offset:5120
    ds_read_b128 v[124:127], v44
    ds_read_b64_tr_b16 v[128:129], v40 offset:8192
    ds_read_b64_tr_b16 v[130:131], v40 offset:9216
    ds_read_b64_tr_b16 v[132:133], v41 offset:8192
    ds_read_b64_tr_b16 v[134:135], v41 offset:9216
    ds_read_b128 v[136:139], v45
    ds_read_b64_tr_b16 v[140:141], v40 offset:12288
    ds_read_b64_tr_b16 v[142:143], v40 offset:13312
    ds_read_b64_tr_b16 v[144:145], v41 offset:12288
    ds_read_b64_tr_b16 v[146:147], v41 offset:13312
    s_waitcnt lgkmcnt(15)
    v_mfma_f32_32x32x16_bf16 v[64:79], v[104:107], v[100:103], v[64:79]
    v_mfma_f32_32x32x16_bf16 v[80:95], v[108:111], v[100:103], v[80:95]
    s_waitcnt lgkmcnt(10)
    v_mfma_f32_32x32x16_bf16 v[64:79], v[116:119], v[112:115], v[64:79]
    v_mfma_f32_32x32x16_bf16 v[80:95], v[120:123], v[112:115], v[80:95]
    s_waitcnt lgkmcnt(5)
    v_mfma_f32_32x32x16_bf16 v[64:79], v[128:131], v[124:127], v[64:79]
    v_mfma_f32_32x32x16_bf16 v[80:95], v[132:135], v[124:127], v[80:95]
    s_waitcnt lgkmcnt(0)
    v_mfma_f32_32x32x16_bf16 v[64:79], v[140:143], v[136:139], v[64:79]
    v_mfma_f32_32x32x16_bf16 v[80:95], v[144:147], v[136:139], v[80:95]
    s_waitcnt vmcnt(18)
    s_barrier
    s_add_u32 m0, s48, 16384
    s_add_u32 s41, s50, 15
    s_and_b32 s41, s41, 15
    s_lshl_b32 s41, s41, 7
    buffer_load_dwordx4 v14, s[16:19], s41 offen lds
    s_add_u32 m0, s48, 17408
    s_add_u32 s41, s50, 15
    s_and_b32 s41, s41, 15
    s_lshl_b32 s41, s41, 7
    buffer_load_dwordx4 v15, s[16:19], s41 offen lds
    s_add_u32 m0, s49, 0
    s_add_u32 s41, s50, 15
    s_and_b32 s41, s41, 15
    s_lshl_b32 s41, s41, 19
    buffer_load_dwordx4 v10, s[28:31], s41 offen lds
    s_add_u32 m0, s49, 1024
    s_add_u32 s41, s50, 15
    s_and_b32 s41, s41, 15
    s_lshl_b32 s41, s41, 19
    buffer_load_dwordx4 v11, s[28:31], s41 offen lds
    s_add_u32 m0, s49, 2048
    s_add_u32 s41, s50, 15
    s_and_b32 s41, s41, 15
    s_lshl_b32 s41, s41, 19
    buffer_load_dwordx4 v12, s[28:31], s41 offen lds
    s_add_u32 m0, s49, 3072
    s_add_u32 s41, s50, 15
    s_and_b32 s41, s41, 15
    s_lshl_b32 s41, s41, 19
    buffer_load_dwordx4 v13, s[28:31], s41 offen lds
    v_add_u32 v40, 24576, v20
    v_add_u32 v41, 24576, v21
    v_add_u32 v42, 24576, v28
    v_add_u32 v43, 24576, v29
    v_add_u32 v44, 24576, v30
    v_add_u32 v45, 24576, v31
    ds_read_b128 v[100:103], v42
    ds_read_b64_tr_b16 v[104:105], v40 offset:0
    ds_read_b64_tr_b16 v[106:107], v40 offset:1024
    ds_read_b64_tr_b16 v[108:109], v41 offset:0
    ds_read_b64_tr_b16 v[110:111], v41 offset:1024
    ds_read_b128 v[112:115], v43
    ds_read_b64_tr_b16 v[116:117], v40 offset:4096
    ds_read_b64_tr_b16 v[118:119], v40 offset:5120
    ds_read_b64_tr_b16 v[120:121], v41 offset:4096
    ds_read_b64_tr_b16 v[122:123], v41 offset:5120
    ds_read_b128 v[124:127], v44
    ds_read_b64_tr_b16 v[128:129], v40 offset:8192
    ds_read_b64_tr_b16 v[130:131], v40 offset:9216
    ds_read_b64_tr_b16 v[132:133], v41 offset:8192
    ds_read_b64_tr_b16 v[134:135], v41 offset:9216
    ds_read_b128 v[136:139], v45
    ds_read_b64_tr_b16 v[140:141], v40 offset:12288
    ds_read_b64_tr_b16 v[142:143], v40 offset:13312
    ds_read_b64_tr_b16 v[144:145], v41 offset:12288
    ds_read_b64_tr_b16 v[146:147], v41 offset:13312
    s_waitcnt lgkmcnt(15)
    v_mfma_f32_32x32x16_bf16 v[64:79], v[104:107], v[100:103], v[64:79]
    v_mfma_f32_32x32x16_bf16 v[80:95], v[108:111], v[100:103], v[80:95]
    s_waitcnt lgkmcnt(10)
    v_mfma_f32_32x32x16_bf16 v[64:79], v[116:119], v[112:115], v[64:79]
    v_mfma_f32_32x32x16_bf16 v[80:95], v[120:123], v[112:115], v[80:95]
    s_waitcnt lgkmcnt(5)
    v_mfma_f32_32x32x16_bf16 v[64:79], v[128:131], v[124:127], v[64:79]
    v_mfma_f32_32x32x16_bf16 v[80:95], v[132:135], v[124:127], v[80:95]
    s_waitcnt lgkmcnt(0)
    v_mfma_f32_32x32x16_bf16 v[64:79], v[140:143], v[136:139], v[64:79]
    v_mfma_f32_32x32x16_bf16 v[80:95], v[144:147], v[136:139], v[80:95]
    s_waitcnt vmcnt(18)
    s_barrier
    v_add_u32 v40, 49152, v20
    v_add_u32 v41, 49152, v21
    v_add_u32 v42, 49152, v28
    v_add_u32 v43, 49152, v29
    v_add_u32 v44, 49152, v30
    v_add_u32 v45, 49152, v31
    ds_read_b128 v[100:103], v42
    ds_read_b64_tr_b16 v[104:105], v40 offset:0
    ds_read_b64_tr_b16 v[106:107], v40 offset:1024
    ds_read_b64_tr_b16 v[108:109], v41 offset:0
    ds_read_b64_tr_b16 v[110:111], v41 offset:1024
    ds_read_b128 v[112:115], v43
    ds_read_b64_tr_b16 v[116:117], v40 offset:4096
    ds_read_b64_tr_b16 v[118:119], v40 offset:5120
    ds_read_b64_tr_b16 v[120:121], v41 offset:4096
    ds_read_b64_tr_b16 v[122:123], v41 offset:5120
    ds_read_b128 v[124:127], v44
    ds_read_b64_tr_b16 v[128:129], v40 offset:8192
    ds_read_b64_tr_b16 v[130:131], v40 offset:9216
    ds_read_b64_tr_b16 v[132:133], v41 offset:8192
    ds_read_b64_tr_b16 v[134:135], v41 offset:9216
    ds_read_b128 v[136:139], v45
    ds_read_b64_tr_b16 v[140:141], v40 offset:12288
    ds_read_b64_tr_b16 v[142:143], v40 offset:13312
    ds_read_b64_tr_b16 v[144:145], v41 offset:12288
    ds_read_b64_tr_b16 v[146:147], v41 offset:13312
    s_waitcnt lgkmcnt(15)
    v_mfma_f32_32x32x16_bf16 v[64:79], v[104:107], v[100:103], v[64:79]
    v_mfma_f32_32x32x16_bf16 v[80:95], v[108:111], v[100:103], v[80:95]
    s_waitcnt lgkmcnt(10)
    v_mfma_f32_32x32x16_bf16 v[64:79], v[116:119], v[112:115], v[64:79]
    v_mfma_f32_32x32x16_bf16 v[80:95], v[120:123], v[112:115], v[80:95]
    s_waitcnt lgkmcnt(5)
    v_mfma_f32_32x32x16_bf16 v[64:79], v[128:131], v[124:127], v[64:79]
    v_mfma_f32_32x32x16_bf16 v[80:95], v[132:135], v[124:127], v[80:95]
    s_waitcnt lgkmcnt(0)
    v_mfma_f32_32x32x16_bf16 v[64:79], v[140:143], v[136:139], v[64:79]
    v_mfma_f32_32x32x16_bf16 v[80:95], v[144:147], v[136:139], v[80:95]
    s_waitcnt vmcnt(12)
    s_barrier
    v_add_u32 v40, 73728, v20
    v_add_u32 v41, 73728, v21
    v_add_u32 v42, 73728, v28
    v_add_u32 v43, 73728, v29
    v_add_u32 v44, 73728, v30
    v_add_u32 v45, 73728, v31
    ds_read_b128 v[100:103], v42
    ds_read_b64_tr_b16 v[104:105], v40 offset:0
    ds_read_b64_tr_b16 v[106:107], v40 offset:1024
    ds_read_b64_tr_b16 v[108:109], v41 offset:0
    ds_read_b64_tr_b16 v[110:111], v41 offset:1024
    ds_read_b128 v[112:115], v43
    ds_read_b64_tr_b16 v[116:117], v40 offset:4096
    ds_read_b64_tr_b16 v[118:119], v40 offset:5120
    ds_read_b64_tr_b16 v[120:121], v41 offset:4096
    ds_read_b64_tr_b16 v[122:123], v41 offset:5120
    ds_read_b128 v[124:127], v44
    ds_read_b64_tr_b16 v[128:129], v40 offset:8192
    ds_read_b64_tr_b16 v[130:131], v40 offset:9216
    ds_read_b64_tr_b16 v[132:133], v41 offset:8192
    ds_read_b64_tr_b16 v[134:135], v41 offset:9216
    ds_read_b128 v[136:139], v45
    ds_read_b64_tr_b16 v[140:141], v40 offset:12288
    ds_read_b64_tr_b16 v[142:143], v40 offset:13312
    ds_read_b64_tr_b16 v[144:145], v41 offset:12288
    ds_read_b64_tr_b16 v[146:147], v41 offset:13312
    s_waitcnt lgkmcnt(15)
    v_mfma_f32_32x32x16_bf16 v[64:79], v[104:107], v[100:103], v[64:79]
    v_mfma_f32_32x32x16_bf16 v[80:95], v[108:111], v[100:103], v[80:95]
    s_waitcnt lgkmcnt(10)
    v_mfma_f32_32x32x16_bf16 v[64:79], v[116:119], v[112:115], v[64:79]
    v_mfma_f32_32x32x16_bf16 v[80:95], v[120:123], v[112:115], v[80:95]
    s_waitcnt lgkmcnt(5)
    v_mfma_f32_32x32x16_bf16 v[64:79], v[128:131], v[124:127], v[64:79]
    v_mfma_f32_32x32x16_bf16 v[80:95], v[132:135], v[124:127], v[80:95]
    s_waitcnt lgkmcnt(0)
    v_mfma_f32_32x32x16_bf16 v[64:79], v[140:143], v[136:139], v[64:79]
    v_mfma_f32_32x32x16_bf16 v[80:95], v[144:147], v[136:139], v[80:95]
    s_waitcnt vmcnt(6)
    s_barrier
    v_add_u32 v40, 98304, v20
    v_add_u32 v41, 98304, v21
    v_add_u32 v42, 98304, v28
    v_add_u32 v43, 98304, v29
    v_add_u32 v44, 98304, v30
    v_add_u32 v45, 98304, v31
    ds_read_b128 v[100:103], v42
    ds_read_b64_tr_b16 v[104:105], v40 offset:0
    ds_read_b64_tr_b16 v[106:107], v40 offset:1024
    ds_read_b64_tr_b16 v[108:109], v41 offset:0
    ds_read_b64_tr_b16 v[110:111], v41 offset:1024
    ds_read_b128 v[112:115], v43
    ds_read_b64_tr_b16 v[116:117], v40 offset:4096
    ds_read_b64_tr_b16 v[118:119], v40 offset:5120
    ds_read_b64_tr_b16 v[120:121], v41 offset:4096
    ds_read_b64_tr_b16 v[122:123], v41 offset:5120
    ds_read_b128 v[124:127], v44
    ds_read_b64_tr_b16 v[128:129], v40 offset:8192
    ds_read_b64_tr_b16 v[130:131], v40 offset:9216
    ds_read_b64_tr_b16 v[132:133], v41 offset:8192
    ds_read_b64_tr_b16 v[134:135], v41 offset:9216
    ds_read_b128 v[136:139], v45
    ds_read_b64_tr_b16 v[140:141], v40 offset:12288
    ds_read_b64_tr_b16 v[142:143], v40 offset:13312
    ds_read_b64_tr_b16 v[144:145], v41 offset:12288
    ds_read_b64_tr_b16 v[146:147], v41 offset:13312
    s_waitcnt lgkmcnt(15)
    v_mfma_f32_32x32x16_bf16 v[64:79], v[104:107], v[100:103], v[64:79]
    v_mfma_f32_32x32x16_bf16 v[80:95], v[108:111], v[100:103], v[80:95]
    s_waitcnt lgkmcnt(10)
    v_mfma_f32_32x32x16_bf16 v[64:79], v[116:119], v[112:115], v[64:79]
    v_mfma_f32_32x32x16_bf16 v[80:95], v[120:123], v[112:115], v[80:95]
    s_waitcnt lgkmcnt(5)
    v_mfma_f32_32x32x16_bf16 v[64:79], v[128:131], v[124:127], v[64:79]
    v_mfma_f32_32x32x16_bf16 v[80:95], v[132:135], v[124:127], v[80:95]
    s_waitcnt lgkmcnt(0)
    v_mfma_f32_32x32x16_bf16 v[64:79], v[140:143], v[136:139], v[64:79]
    v_mfma_f32_32x32x16_bf16 v[80:95], v[144:147], v[136:139], v[80:95]
    s_waitcnt vmcnt(0)
    s_barrier
    v_add_u32 v40, 0, v20
    v_add_u32 v41, 0, v21
    v_add_u32 v42, 0, v28
    v_add_u32 v43, 0, v29
    v_add_u32 v44, 0, v30
    v_add_u32 v45, 0, v31
    ds_read_b128 v[100:103], v42
    ds_read_b64_tr_b16 v[104:105], v40 offset:0
    ds_read_b64_tr_b16 v[106:107], v40 offset:1024
    ds_read_b64_tr_b16 v[108:109], v41 offset:0
    ds_read_b64_tr_b16 v[110:111], v41 offset:1024
    ds_read_b128 v[112:115], v43
    ds_read_b64_tr_b16 v[116:117], v40 offset:4096
    ds_read_b64_tr_b16 v[118:119], v40 offset:5120
    ds_read_b64_tr_b16 v[120:121], v41 offset:4096
    ds_read_b64_tr_b16 v[122:123], v41 offset:5120
    ds_read_b128 v[124:127], v44
    ds_read_b64_tr_b16 v[128:129], v40 offset:8192
    ds_read_b64_tr_b16 v[130:131], v40 offset:9216
    ds_read_b64_tr_b16 v[132:133], v41 offset:8192
    ds_read_b64_tr_b16 v[134:135], v41 offset:9216
    ds_read_b128 v[136:139], v45
    ds_read_b64_tr_b16 v[140:141], v40 offset:12288
    ds_read_b64_tr_b16 v[142:143], v40 offset:13312
    ds_read_b64_tr_b16 v[144:145], v41 offset:12288
    ds_read_b64_tr_b16 v[146:147], v41 offset:13312
    s_waitcnt lgkmcnt(15)
    v_mfma_f32_32x32x16_bf16 v[64:79], v[104:107], v[100:103], v[64:79]
    v_mfma_f32_32x32x16_bf16 v[80:95], v[108:111], v[100:103], v[80:95]
    s_waitcnt lgkmcnt(10)
    v_mfma_f32_32x32x16_bf16 v[64:79], v[116:119], v[112:115], v[64:79]
    v_mfma_f32_32x32x16_bf16 v[80:95], v[120:123], v[112:115], v[80:95]
    s_waitcnt lgkmcnt(5)
    v_mfma_f32_32x32x16_bf16 v[64:79], v[128:131], v[124:127], v[64:79]
    v_mfma_f32_32x32x16_bf16 v[80:95], v[132:135], v[124:127], v[80:95]
    s_waitcnt lgkmcnt(0)
    v_mfma_f32_32x32x16_bf16 v[64:79], v[140:143], v[136:139], v[64:79]
    v_mfma_f32_32x32x16_bf16 v[80:95], v[144:147], v[136:139], v[80:95]
    s_nop 15
    s_nop 7
    v_cvt_pk_bf16_f32 v100, v64, v65
    v_cvt_pk_bf16_f32 v101, v66, v67
    v_cvt_pk_bf16_f32 v102, v68, v69
    v_cvt_pk_bf16_f32 v103, v70, v71
    v_cvt_pk_bf16_f32 v104, v72, v73
    v_cvt_pk_bf16_f32 v105, v74, v75
    v_cvt_pk_bf16_f32 v106, v76, v77
    v_cvt_pk_bf16_f32 v107, v78, v79
    v_cvt_pk_bf16_f32 v108, v80, v81
    v_cvt_pk_bf16_f32 v109, v82, v83
    v_cvt_pk_bf16_f32 v110, v84, v85
    v_cvt_pk_bf16_f32 v111, v86, v87
    v_cvt_pk_bf16_f32 v112, v88, v89
    v_cvt_pk_bf16_f32 v113, v90, v91
    v_cvt_pk_bf16_f32 v114, v92, v93
    v_cvt_pk_bf16_f32 v115, v94, v95
    v_mov_b32 v128, 0
    v_mov_b32 v129, 0
    v_mov_b32 v130, 0
    v_mov_b32 v131, 0
    v_mov_b32 v132, 0
    v_mov_b32 v133, 0
    v_mov_b32 v134, 0
    v_mov_b32 v135, 0
    v_mov_b32 v136, 0
    v_mov_b32 v137, 0
    v_mov_b32 v138, 0
    v_mov_b32 v139, 0
    v_mov_b32 v140, 0
    v_mov_b32 v141, 0
    v_mov_b32 v142, 0
    v_mov_b32 v143, 0
    s_nop 2
    v_mfma_f32_32x32x16_bf16 v[128:143], v[200:203], v[100:103], v[128:143]
    v_mfma_f32_32x32x16_bf16 v[128:143], v[204:207], v[104:107], v[128:143]
    v_mfma_f32_32x32x16_bf16 v[128:143], v[208:211], v[108:111], v[128:143]
    v_mfma_f32_32x32x16_bf16 v[128:143], v[212:215], v[112:115], v[128:143]
    s_nop 15
    s_nop 7
    s_barrier
    v_lshlrev_b32 v5, 4, v1
    v_add_u32 v6, s49, v5
    s_xor_b32 s45, s49, 4096
    v_add_u32 v7, s45, v5
    ds_write_b128 v6, v[128:131] offset:0
    ds_write_b128 v6, v[132:135] offset:1024
    ds_write_b128 v6, v[136:139] offset:2048
    ds_write_b128 v6, v[140:143] offset:3072
    s_waitcnt lgkmcnt(0)
    s_barrier
    ds_read_b128 v[144:147], v7 offset:0
    ds_read_b128 v[148:151], v7 offset:1024
    ds_read_b128 v[152:155], v7 offset:2048
    ds_read_b128 v[156:159], v7 offset:3072
    s_waitcnt lgkmcnt(0)
    v_add_f32 v128, v128, v144
    v_add_f32 v129, v129, v145
    v_add_f32 v130, v130, v146
    v_add_f32 v131, v131, v147
    v_add_f32 v132, v132, v148
    v_add_f32 v133, v133, v149
    v_add_f32 v134, v134, v150
    v_add_f32 v135, v135, v151
    v_add_f32 v136, v136, v152
    v_add_f32 v137, v137, v153
    v_add_f32 v138, v138, v154
    v_add_f32 v139, v139, v155
    v_add_f32 v140, v140, v156
    v_add_f32 v141, v141, v157
    v_add_f32 v142, v142, v158
    v_add_f32 v143, v143, v159
    v_max_f32 v8, v128, v129
    v_max_f32 v8, v8, v130
    v_max_f32 v8, v8, v131
    v_max_f32 v8, v8, v132
    v_max_f32 v8, v8, v133
    v_max_f32 v8, v8, v134
    v_max_f32 v8, v8, v135
    v_max_f32 v8, v8, v136
    v_max_f32 v8, v8, v137
    v_max_f32 v8, v8, v138
    v_max_f32 v8, v8, v139
    v_max_f32 v8, v8, v140
    v_max_f32 v8, v8, v141
    v_max_f32 v8, v8, v142
    v_max_f32 v8, v8, v143
    v_mov_b32 v9, v8
    s_nop 1
    v_permlane32_swap_b32 v8, v9
    s_nop 1
    v_max_f32 v8, v8, v9
    s_mov_b32 s45, 0x3e0296a9
    v_mov_b32 v10, 0
    v_sub_f32 v128, v128, v8
    v_mul_f32 v128, s45, v128
    v_exp_f32 v128, v128
    s_nop 0
    v_add_f32 v10, v10, v128
    v_sub_f32 v129, v129, v8
    v_mul_f32 v129, s45, v129
    v_exp_f32 v129, v129
    s_nop 0
    v_add_f32 v10, v10, v129
    v_sub_f32 v130, v130, v8
    v_mul_f32 v130, s45, v130
    v_exp_f32 v130, v130
    s_nop 0
    v_add_f32 v10, v10, v130
    v_sub_f32 v131, v131, v8
    v_mul_f32 v131, s45, v131
    v_exp_f32 v131, v131
    s_nop 0
    v_add_f32 v10, v10, v131
    v_sub_f32 v132, v132, v8
    v_mul_f32 v132, s45, v132
    v_exp_f32 v132, v132
    s_nop 0
    v_add_f32 v10, v10, v132
    v_sub_f32 v133, v133, v8
    v_mul_f32 v133, s45, v133
    v_exp_f32 v133, v133
    s_nop 0
    v_add_f32 v10, v10, v133
    v_sub_f32 v134, v134, v8
    v_mul_f32 v134, s45, v134
    v_exp_f32 v134, v134
    s_nop 0
    v_add_f32 v10, v10, v134
    v_sub_f32 v135, v135, v8
    v_mul_f32 v135, s45, v135
    v_exp_f32 v135, v135
    s_nop 0
    v_add_f32 v10, v10, v135
    v_sub_f32 v136, v136, v8
    v_mul_f32 v136, s45, v136
    v_exp_f32 v136, v136
    s_nop 0
    v_add_f32 v10, v10, v136
    v_sub_f32 v137, v137, v8
    v_mul_f32 v137, s45, v137
    v_exp_f32 v137, v137
    s_nop 0
    v_add_f32 v10, v10, v137
    v_sub_f32 v138, v138, v8
    v_mul_f32 v138, s45, v138
    v_exp_f32 v138, v138
    s_nop 0
    v_add_f32 v10, v10, v138
    v_sub_f32 v139, v139, v8
    v_mul_f32 v139, s45, v139
    v_exp_f32 v139, v139
    s_nop 0
    v_add_f32 v10, v10, v139
    v_sub_f32 v140, v140, v8
    v_mul_f32 v140, s45, v140
    v_exp_f32 v140, v140
    s_nop 0
    v_add_f32 v10, v10, v140
    v_sub_f32 v141, v141, v8
    v_mul_f32 v141, s45, v141
    v_exp_f32 v141, v141
    s_nop 0
    v_add_f32 v10, v10, v141
    v_sub_f32 v142, v142, v8
    v_mul_f32 v142, s45, v142
    v_exp_f32 v142, v142
    s_nop 0
    v_add_f32 v10, v10, v142
    v_sub_f32 v143, v143, v8
    v_mul_f32 v143, s45, v143
    v_exp_f32 v143, v143
    s_nop 0
    v_add_f32 v10, v10, v143
    v_mov_b32 v9, v10
    s_nop 1
    v_permlane32_swap_b32 v10, v9
    s_nop 1
    v_add_f32 v10, v10, v9
    v_rcp_f32 v10, v10
    s_nop 1
    v_mul_f32 v128, v128, v10
    v_mul_f32 v129, v129, v10
    v_mul_f32 v130, v130, v10
    v_mul_f32 v131, v131, v10
    v_mul_f32 v132, v132, v10
    v_mul_f32 v133, v133, v10
    v_mul_f32 v134, v134, v10
    v_mul_f32 v135, v135, v10
    v_mul_f32 v136, v136, v10
    v_mul_f32 v137, v137, v10
    v_mul_f32 v138, v138, v10
    v_mul_f32 v139, v139, v10
    v_mul_f32 v140, v140, v10
    v_mul_f32 v141, v141, v10
    v_mul_f32 v142, v142, v10
    v_mul_f32 v143, v143, v10
    v_cvt_pk_bf16_f32 v100, v128, v129
    v_cvt_pk_bf16_f32 v101, v130, v131
    v_cvt_pk_bf16_f32 v102, v132, v133
    v_cvt_pk_bf16_f32 v103, v134, v135
    v_cvt_pk_bf16_f32 v104, v136, v137
    v_cvt_pk_bf16_f32 v105, v138, v139
    v_cvt_pk_bf16_f32 v106, v140, v141
    v_cvt_pk_bf16_f32 v107, v142, v143
    v_lshlrev_b32 v11, 10, v3
    s_lshl_b32 s45, s39, 13
    s_add_u32 s45, s45, 122880
    v_sub_u32 v12, v20, v11
    v_add_u32 v12, s45, v12
    v_sub_u32 v13, v21, v11
    v_add_u32 v13, s45, v13
    ds_read_b64_tr_b16 v[144:145], v12 offset:0
    ds_read_b64_tr_b16 v[146:147], v12 offset:2048
    ds_read_b64_tr_b16 v[148:149], v12 offset:4096
    ds_read_b64_tr_b16 v[150:151], v12 offset:6144
    ds_read_b64_tr_b16 v[152:153], v13 offset:0
    ds_read_b64_tr_b16 v[154:155], v13 offset:2048
    ds_read_b64_tr_b16 v[156:157], v13 offset:4096
    ds_read_b64_tr_b16 v[158:159], v13 offset:6144
    v_mov_b32 v64, 0
    v_mov_b32 v65, 0
    v_mov_b32 v66, 0
    v_mov_b32 v67, 0
    v_mov_b32 v68, 0
    v_mov_b32 v69, 0
    v_mov_b32 v70, 0
    v_mov_b32 v71, 0
    v_mov_b32 v72, 0
    v_mov_b32 v73, 0
    v_mov_b32 v74, 0
    v_mov_b32 v75, 0
    v_mov_b32 v76, 0
    v_mov_b32 v77, 0
    v_mov_b32 v78, 0
    v_mov_b32 v79, 0
    v_mov_b32 v80, 0
    v_mov_b32 v81, 0
    v_mov_b32 v82, 0
    v_mov_b32 v83, 0
    v_mov_b32 v84, 0
    v_mov_b32 v85, 0
    v_mov_b32 v86, 0
    v_mov_b32 v87, 0
    v_mov_b32 v88, 0
    v_mov_b32 v89, 0
    v_mov_b32 v90, 0
    v_mov_b32 v91, 0
    v_mov_b32 v92, 0
    v_mov_b32 v93, 0
    v_mov_b32 v94, 0
    v_mov_b32 v95, 0
    s_waitcnt lgkmcnt(0)
    v_mfma_f32_32x32x16_bf16 v[64:79], v[144:147], v[100:103], v[64:79]
    v_mfma_f32_32x32x16_bf16 v[64:79], v[148:151], v[104:107], v[64:79]
    v_mfma_f32_32x32x16_bf16 v[80:95], v[152:155], v[100:103], v[80:95]
    v_mfma_f32_32x32x16_bf16 v[80:95], v[156:159], v[104:107], v[80:95]
    s_nop 15
    s_nop 7
    s_lshl_b32 s45, s43, 8
    s_lshl_b32 s46, s37, 3
    s_add_u32 s45, s45, s46
    s_lshl_b32 s46, s40, 2
    s_add_u32 s45, s45, s46
    s_lshl_b32 s45, s45, 10
    v_cvt_pk_bf16_f32 v100, v64, v65
    v_cvt_pk_bf16_f32 v101, v66, v67
    v_cvt_pk_bf16_f32 v102, v68, v69
    v_cvt_pk_bf16_f32 v103, v70, v71
    s_nop 1
    buffer_store_dwordx4 v[100:103], v5, s[32:35], s45 offen offset:0
    v_cvt_pk_bf16_f32 v104, v72, v73
    v_cvt_pk_bf16_f32 v105, v74, v75
    v_cvt_pk_bf16_f32 v106, v76, v77
    v_cvt_pk_bf16_f32 v107, v78, v79
    s_nop 1
    buffer_store_dwordx4 v[104:107], v5, s[32:35], s45 offen offset:1024
    v_cvt_pk_bf16_f32 v108, v80, v81
    v_cvt_pk_bf16_f32 v109, v82, v83
    v_cvt_pk_bf16_f32 v110, v84, v85
    v_cvt_pk_bf16_f32 v111, v86, v87
    s_nop 1
    buffer_store_dwordx4 v[108:111], v5, s[32:35], s45 offen offset:2048
    v_cvt_pk_bf16_f32 v112, v88, v89
    v_cvt_pk_bf16_f32 v113, v90, v91
    v_cvt_pk_bf16_f32 v114, v92, v93
    v_cvt_pk_bf16_f32 v115, v94, v95
    s_nop 1
    buffer_store_dwordx4 v[112:115], v5, s[32:35], s45 offen offset:3072
k1_end:
    s_endpgm
.globl k2_kernel
.p2align 8
.type k2_kernel,@function
k2_kernel:
    s_cmp_ge_u32 s2, 256
    s_cbranch_scc1 k2_end
    s_load_dwordx2 s[4:5], s[0:1], 32
    s_load_dwordx2 s[12:13], s[0:1], 56
    v_lshrrev_b32 v2, 6, v0
    v_and_b32 v1, 63, v0
    s_nop 0
    v_readfirstlane_b32 s36, v2
    s_and_b32 s39, s2, 7
    s_lshr_b32 s3, s2, 3
    s_and_b32 s38, s3, 3
    s_lshr_b32 s37, s3, 2
    s_lshr_b32 s40, s36, 1
    s_and_b32 s42, s36, 1
    s_waitcnt lgkmcnt(0)
    s_mov_b32 s16, s4
    s_mov_b32 s17, s5
    s_mov_b32 s18, 8388608
    s_mov_b32 s19, 0x00020000
    s_mov_b32 s32, s12
    s_mov_b32 s33, s13
    s_mov_b32 s34, 20971520
    s_mov_b32 s35, 0x00020000
    v_lshrrev_b32 v3, 5, v1
    v_lshrrev_b32 v6, 4, v1
    v_and_b32 v7, 15, v1
    v_lshlrev_b32 v8, 2, v6
    v_xor_b32 v7, v7, v8
    s_lshl_b32 s45, s39, 20
    s_lshl_b32 s46, s36, 15
    s_add_u32 s45, s45, s46
    s_lshl_b32 s46, s37, 8
    s_add_u32 s45, s45, s46
    v_lshlrev_b32 v10, 11, v6
    v_lshl_add_u32 v10, v7, 4, v10
    v_add_u32 v10, s45, v10
    v_add_u32 v11, 8192, v10
    v_add_u32 v12, 16384, v10
    v_add_u32 v13, 24576, v10
    s_lshl_b32 s45, s38, 2
    s_add_u32 s45, s45, s36
    s_lshl_b32 s45, s45, 8
    s_lshl_b32 s46, s39, 5
    s_add_u32 s45, s45, s46
    s_lshl_b32 s45, s45, 10
    v_lshlrev_b32 v5, 4, v1
    v_add_u32 v14, s45, v5
    v_bfe_u32 v22, v1, 2, 2
    v_and_b32 v23, 3, v1
    v_bfe_u32 v24, v1, 4, 1
    v_lshlrev_b32 v24, 1, v24
    v_lshrrev_b32 v25, 1, v23
    v_add_u32 v24, v24, v25
    s_lshl_b32 s45, s42, 3
    v_add_u32 v24, s45, v24
    v_lshl_add_u32 v25, v3, 2, v22
    v_lshlrev_b32 v25, 8, v25
    v_and_b32 v26, 1, v23
    v_lshl_add_u32 v25, v26, 3, v25
    v_add_u32 v26, 0, v24
    v_lshlrev_b32 v27, 2, v22
    v_xor_b32 v26, v26, v27
    v_lshl_add_u32 v20, v26, 4, v25
    v_add_u32 v26, 4, v24
    v_lshlrev_b32 v27, 2, v22
    v_xor_b32 v26, v26, v27
    v_lshl_add_u32 v21, v26, 4, v25
    s_lshl_b32 s45, s40, 13
    s_add_u32 s45, s45, 16384
    v_add_u32 v28, s45, v5
    v_mov_b32 v64, 0
    v_mov_b32 v65, 0
    v_mov_b32 v66, 0
    v_mov_b32 v67, 0
    v_mov_b32 v68, 0
    v_mov_b32 v69, 0
    v_mov_b32 v70, 0
    v_mov_b32 v71, 0
    v_mov_b32 v72, 0
    v_mov_b32 v73, 0
    v_mov_b32 v74, 0
    v_mov_b32 v75, 0
    v_mov_b32 v76, 0
    v_mov_b32 v77, 0
    v_mov_b32 v78, 0
    v_mov_b32 v79, 0
    v_mov_b32 v80, 0
    v_mov_b32 v81, 0
    v_mov_b32 v82, 0
    v_mov_b32 v83, 0
    v_mov_b32 v84, 0
    v_mov_b32 v85, 0
    v_mov_b32 v86, 0
    v_mov_b32 v87, 0
    v_mov_b32 v88, 0
    v_mov_b32 v89, 0
    v_mov_b32 v90, 0
    v_mov_b32 v91, 0
    v_mov_b32 v92, 0
    v_mov_b32 v93, 0
    v_mov_b32 v94, 0
    v_mov_b32 v95, 0
    v_mov_b32 v96, 0
    v_mov_b32 v97, 0
    v_mov_b32 v98, 0
    v_mov_b32 v99, 0
    v_mov_b32 v100, 0
    v_mov_b32 v101, 0
    v_mov_b32 v102, 0
    v_mov_b32 v103, 0
    v_mov_b32 v104, 0
    v_mov_b32 v105, 0
    v_mov_b32 v106, 0
    v_mov_b32 v107, 0
    v_mov_b32 v108, 0
    v_mov_b32 v109, 0
    v_mov_b32 v110, 0
    v_mov_b32 v111, 0
    v_mov_b32 v112, 0
    v_mov_b32 v113, 0
    v_mov_b32 v114, 0
    v_mov_b32 v115, 0
    v_mov_b32 v116, 0
    v_mov_b32 v117, 0
    v_mov_b32 v118, 0
    v_mov_b32 v119, 0
    v_mov_b32 v120, 0
    v_mov_b32 v121, 0
    v_mov_b32 v122, 0
    v_mov_b32 v123, 0
    v_mov_b32 v124, 0
    v_mov_b32 v125, 0
    v_mov_b32 v126, 0
    v_mov_b32 v127, 0
    s_lshl_b32 s49, s36, 12
    s_add_u32 m0, s49, 0
    s_mov_b32 s41, 0
    buffer_load_dwordx4 v10, s[16:19], s41 offen lds
    s_add_u32 m0, s49, 1024
    s_mov_b32 s41, 0
    buffer_load_dwordx4 v11, s[16:19], s41 offen lds
    s_add_u32 m0, s49, 2048
    s_mov_b32 s41, 0
    buffer_load_dwordx4 v12, s[16:19], s41 offen lds
    s_add_u32 m0, s49, 3072
    s_mov_b32 s41, 0
    buffer_load_dwordx4 v13, s[16:19], s41 offen lds
    s_add_u32 m0, s49, 16384
    s_mov_b32 s41, 0
    buffer_load_dwordx4 v14, s[32:35], s41 offen lds
    s_add_u32 m0, s49, 17408
    s_mov_b32 s41, 1024
    buffer_load_dwordx4 v14, s[32:35], s41 offen lds
    s_add_u32 m0, s49, 18432
    s_mov_b32 s41, 2048
    buffer_load_dwordx4 v14, s[32:35], s41 offen lds
    s_add_u32 m0, s49, 19456
    s_mov_b32 s41, 3072
    buffer_load_dwordx4 v14, s[32:35], s41 offen lds
    s_add_u32 m0, s49, 32768
    s_mov_b32 s41, 131072
    buffer_load_dwordx4 v10, s[16:19], s41 offen lds
    s_add_u32 m0, s49, 33792
    s_mov_b32 s41, 131072
    buffer_load_dwordx4 v11, s[16:19], s41 offen lds
    s_add_u32 m0, s49, 34816
    s_mov_b32 s41, 131072
    buffer_load_dwordx4 v12, s[16:19], s41 offen lds
    s_add_u32 m0, s49, 35840
    s_mov_b32 s41, 131072
    buffer_load_dwordx4 v13, s[16:19], s41 offen lds
    s_add_u32 m0, s49, 49152
    s_mov_b32 s41, 4096
    buffer_load_dwordx4 v14, s[32:35], s41 offen lds
    s_add_u32 m0, s49, 50176
    s_mov_b32 s41, 5120
    buffer_load_dwordx4 v14, s[32:35], s41 offen lds
    s_add_u32 m0, s49, 51200
    s_mov_b32 s41, 6144
    buffer_load_dwordx4 v14, s[32:35], s41 offen lds
    s_add_u32 m0, s49, 52224
    s_mov_b32 s41, 7168
    buffer_load_dwordx4 v14, s[32:35], s41 offen lds
    s_add_u32 m0, s49, 65536
    s_mov_b32 s41, 262144
    buffer_load_dwordx4 v10, s[16:19], s41 offen lds
    s_add_u32 m0, s49, 66560
    s_mov_b32 s41, 262144
    buffer_load_dwordx4 v11, s[16:19], s41 offen lds
    s_add_u32 m0, s49, 67584
    s_mov_b32 s41, 262144
    buffer_load_dwordx4 v12, s[16:19], s41 offen lds
    s_add_u32 m0, s49, 68608
    s_mov_b32 s41, 262144
    buffer_load_dwordx4 v13, s[16:19], s41 offen lds
    s_add_u32 m0, s49, 81920
    s_mov_b32 s41, 8192
    buffer_load_dwordx4 v14, s[32:35], s41 offen lds
    s_add_u32 m0, s49, 82944
    s_mov_b32 s41, 9216
    buffer_load_dwordx4 v14, s[32:35], s41 offen lds
    s_add_u32 m0, s49, 83968
    s_mov_b32 s41, 10240
    buffer_load_dwordx4 v14, s[32:35], s41 offen lds
    s_add_u32 m0, s49, 84992
    s_mov_b32 s41, 11264
    buffer_load_dwordx4 v14, s[32:35], s41 offen lds
    s_waitcnt vmcnt(16)
    s_barrier
    s_add_u32 m0, s49, 98304
    s_mov_b32 s41, 393216
    buffer_load_dwordx4 v10, s[16:19], s41 offen lds
    s_add_u32 m0, s49, 99328
    s_mov_b32 s41, 393216
    buffer_load_dwordx4 v11, s[16:19], s41 offen lds
    s_add_u32 m0, s49, 100352
    s_mov_b32 s41, 393216
    buffer_load_dwordx4 v12, s[16:19], s41 offen lds
    s_add_u32 m0, s49, 101376
    s_mov_b32 s41, 393216
    buffer_load_dwordx4 v13, s[16:19], s41 offen lds
    s_add_u32 m0, s49, 114688
    s_mov_b32 s41, 12288
    buffer_load_dwordx4 v14, s[32:35], s41 offen lds
    s_add_u32 m0, s49, 115712
    s_mov_b32 s41, 13312
    buffer_load_dwordx4 v14, s[32:35], s41 offen lds
    s_add_u32 m0, s49, 116736
    s_mov_b32 s41, 14336
    buffer_load_dwordx4 v14, s[32:35], s41 offen lds
    s_add_u32 m0, s49, 117760
    s_mov_b32 s41, 15360
    buffer_load_dwordx4 v14, s[32:35], s41 offen lds
    v_add_u32 v40, 0, v20
    v_add_u32 v41, 0, v21
    v_add_u32 v42, 0, v28
    ds_read_b128 v[128:131], v42 offset:0
    ds_read_b128 v[132:135], v42 offset:4096
    ds_read_b64_tr_b16 v[136:137], v40 offset:0
    ds_read_b64_tr_b16 v[138:139], v40 offset:2048
    ds_read_b64_tr_b16 v[140:141], v41 offset:0
    ds_read_b64_tr_b16 v[142:143], v41 offset:2048
    ds_read_b128 v[144:147], v42 offset:1024
    ds_read_b128 v[148:151], v42 offset:5120
    ds_read_b64_tr_b16 v[152:153], v40 offset:4096
    ds_read_b64_tr_b16 v[154:155], v40 offset:6144
    ds_read_b64_tr_b16 v[156:157], v41 offset:4096
    ds_read_b64_tr_b16 v[158:159], v41 offset:6144
    s_waitcnt lgkmcnt(6)
    v_mfma_f32_32x32x16_bf16 v[64:79], v[136:139], v[128:131], v[64:79]
    v_mfma_f32_32x32x16_bf16 v[80:95], v[140:143], v[128:131], v[80:95]
    v_mfma_f32_32x32x16_bf16 v[96:111], v[136:139], v[132:135], v[96:111]
    v_mfma_f32_32x32x16_bf16 v[112:127], v[140:143], v[132:135], v[112:127]
    ds_read_b128 v[160:163], v42 offset:2048
    ds_read_b128 v[164:167], v42 offset:6144
    ds_read_b64_tr_b16 v[168:169], v40 offset:8192
    ds_read_b64_tr_b16 v[170:171], v40 offset:10240
    ds_read_b64_tr_b16 v[172:173], v41 offset:8192
    ds_read_b64_tr_b16 v[174:175], v41 offset:10240
    s_waitcnt lgkmcnt(6)
    v_mfma_f32_32x32x16_bf16 v[64:79], v[152:155], v[144:147], v[64:79]
    v_mfma_f32_32x32x16_bf16 v[80:95], v[156:159], v[144:147], v[80:95]
    v_mfma_f32_32x32x16_bf16 v[96:111], v[152:155], v[148:151], v[96:111]
    v_mfma_f32_32x32x16_bf16 v[112:127], v[156:159], v[148:151], v[112:127]
    ds_read_b128 v[176:179], v42 offset:3072
    ds_read_b128 v[180:183], v42 offset:7168
    ds_read_b64_tr_b16 v[184:185], v40 offset:12288
    ds_read_b64_tr_b16 v[186:187], v40 offset:14336
    ds_read_b64_tr_b16 v[188:189], v41 offset:12288
    ds_read_b64_tr_b16 v[190:191], v41 offset:14336
    s_waitcnt lgkmcnt(6)
    v_mfma_f32_32x32x16_bf16 v[64:79], v[168:171], v[160:163], v[64:79]
    v_mfma_f32_32x32x16_bf16 v[80:95], v[172:175], v[160:163], v[80:95]
    v_mfma_f32_32x32x16_bf16 v[96:111], v[168:171], v[164:167], v[96:111]
    v_mfma_f32_32x32x16_bf16 v[112:127], v[172:175], v[164:167], v[112:127]
    s_waitcnt lgkmcnt(0)
    v_mfma_f32_32x32x16_bf16 v[64:79], v[184:187], v[176:179], v[64:79]
    v_mfma_f32_32x32x16_bf16 v[80:95], v[188:191], v[176:179], v[80:95]
    v_mfma_f32_32x32x16_bf16 v[96:111], v[184:187], v[180:183], v[96:111]
    v_mfma_f32_32x32x16_bf16 v[112:127], v[188:191], v[180:183], v[112:127]
    s_waitcnt vmcnt(16)
    s_barrier
    s_add_u32 m0, s49, 0
    s_mov_b32 s41, 524288
    buffer_load_dwordx4 v10, s[16:19], s41 offen lds
    s_add_u32 m0, s49, 1024
    s_mov_b32 s41, 524288
    buffer_load_dwordx4 v11, s[16:19], s41 offen lds
    s_add_u32 m0, s49, 2048
    s_mov_b32 s41, 524288
    buffer_load_dwordx4 v12, s[16:19], s41 offen lds
    s_add_u32 m0, s49, 3072
    s_mov_b32 s41, 524288
    buffer_load_dwordx4 v13, s[16:19], s41 offen lds
    s_add_u32 m0, s49, 16384
    s_mov_b32 s41, 16384
    buffer_load_dwordx4 v14, s[32:35], s41 offen lds
    s_add_u32 m0, s49, 17408
    s_mov_b32 s41, 17408
    buffer_load_dwordx4 v14, s[32:35], s41 offen lds
    s_add_u32 m0, s49, 18432
    s_mov_b32 s41, 18432
    buffer_load_dwordx4 v14, s[32:35], s41 offen lds
    s_add_u32 m0, s49, 19456
    s_mov_b32 s41, 19456
    buffer_load_dwordx4 v14, s[32:35], s41 offen lds
    v_add_u32 v40, 32768, v20
    v_add_u32 v41, 32768, v21
    v_add_u32 v42, 32768, v28
    ds_read_b128 v[128:131], v42 offset:0
    ds_read_b128 v[132:135], v42 offset:4096
    ds_read_b64_tr_b16 v[136:137], v40 offset:0
    ds_read_b64_tr_b16 v[138:139], v40 offset:2048
    ds_read_b64_tr_b16 v[140:141], v41 offset:0
    ds_read_b64_tr_b16 v[142:143], v41 offset:2048
    ds_read_b128 v[144:147], v42 offset:1024
    ds_read_b128 v[148:151], v42 offset:5120
    ds_read_b64_tr_b16 v[152:153], v40 offset:4096
    ds_read_b64_tr_b16 v[154:155], v40 offset:6144
    ds_read_b64_tr_b16 v[156:157], v41 offset:4096
    ds_read_b64_tr_b16 v[158:159], v41 offset:6144
    s_waitcnt lgkmcnt(6)
    v_mfma_f32_32x32x16_bf16 v[64:79], v[136:139], v[128:131], v[64:79]
    v_mfma_f32_32x32x16_bf16 v[80:95], v[140:143], v[128:131], v[80:95]
    v_mfma_f32_32x32x16_bf16 v[96:111], v[136:139], v[132:135], v[96:111]
    v_mfma_f32_32x32x16_bf16 v[112:127], v[140:143], v[132:135], v[112:127]
    ds_read_b128 v[160:163], v42 offset:2048
    ds_read_b128 v[164:167], v42 offset:6144
    ds_read_b64_tr_b16 v[168:169], v40 offset:8192
    ds_read_b64_tr_b16 v[170:171], v40 offset:10240
    ds_read_b64_tr_b16 v[172:173], v41 offset:8192
    ds_read_b64_tr_b16 v[174:175], v41 offset:10240
    s_waitcnt lgkmcnt(6)
    v_mfma_f32_32x32x16_bf16 v[64:79], v[152:155], v[144:147], v[64:79]
    v_mfma_f32_32x32x16_bf16 v[80:95], v[156:159], v[144:147], v[80:95]
    v_mfma_f32_32x32x16_bf16 v[96:111], v[152:155], v[148:151], v[96:111]
    v_mfma_f32_32x32x16_bf16 v[112:127], v[156:159], v[148:151], v[112:127]
    ds_read_b128 v[176:179], v42 offset:3072
    ds_read_b128 v[180:183], v42 offset:7168
    ds_read_b64_tr_b16 v[184:185], v40 offset:12288
    ds_read_b64_tr_b16 v[186:187], v40 offset:14336
    ds_read_b64_tr_b16 v[188:189], v41 offset:12288
    ds_read_b64_tr_b16 v[190:191], v41 offset:14336
    s_waitcnt lgkmcnt(6)
    v_mfma_f32_32x32x16_bf16 v[64:79], v[168:171], v[160:163], v[64:79]
    v_mfma_f32_32x32x16_bf16 v[80:95], v[172:175], v[160:163], v[80:95]
    v_mfma_f32_32x32x16_bf16 v[96:111], v[168:171], v[164:167], v[96:111]
    v_mfma_f32_32x32x16_bf16 v[112:127], v[172:175], v[164:167], v[112:127]
    s_waitcnt lgkmcnt(0)
    v_mfma_f32_32x32x16_bf16 v[64:79], v[184:187], v[176:179], v[64:79]
    v_mfma_f32_32x32x16_bf16 v[80:95], v[188:191], v[176:179], v[80:95]
    v_mfma_f32_32x32x16_bf16 v[96:111], v[184:187], v[180:183], v[96:111]
    v_mfma_f32_32x32x16_bf16 v[112:127], v[188:191], v[180:183], v[112:127]
    s_waitcnt vmcnt(16)
    s_barrier
    s_add_u32 m0, s49, 32768
    s_mov_b32 s41, 655360
    buffer_load_dwordx4 v10, s[16:19], s41 offen lds
    s_add_u32 m0, s49, 33792
    s_mov_b32 s41, 655360
    buffer_load_dwordx4 v11, s[16:19], s41 offen lds
    s_add_u32 m0, s49, 34816
    s_mov_b32 s41, 655360
    buffer_load_dwordx4 v12, s[16:19], s41 offen lds
    s_add_u32 m0, s49, 35840
    s_mov_b32 s41, 655360
    buffer_load_dwordx4 v13, s[16:19], s41 offen lds
    s_add_u32 m0, s49, 49152
    s_mov_b32 s41, 20480
    buffer_load_dwordx4 v14, s[32:35], s41 offen lds
    s_add_u32 m0, s49, 50176
    s_mov_b32 s41, 21504
    buffer_load_dwordx4 v14, s[32:35], s41 offen lds
    s_add_u32 m0, s49, 51200
    s_mov_b32 s41, 22528
    buffer_load_dwordx4 v14, s[32:35], s41 offen lds
    s_add_u32 m0, s49, 52224
    s_mov_b32 s41, 23552
    buffer_load_dwordx4 v14, s[32:35], s41 offen lds
    v_add_u32 v40, 65536, v20
    v_add_u32 v41, 65536, v21
    v_add_u32 v42, 65536, v28
    ds_read_b128 v[128:131], v42 offset:0
    ds_read_b128 v[132:135], v42 offset:4096
    ds_read_b64_tr_b16 v[136:137], v40 offset:0
    ds_read_b64_tr_b16 v[138:139], v40 offset:2048
    ds_read_b64_tr_b16 v[140:141], v41 offset:0
    ds_read_b64_tr_b16 v[142:143], v41 offset:2048
    ds_read_b128 v[144:147], v42 offset:1024
    ds_read_b128 v[148:151], v42 offset:5120
    ds_read_b64_tr_b16 v[152:153], v40 offset:4096
    ds_read_b64_tr_b16 v[154:155], v40 offset:6144
    ds_read_b64_tr_b16 v[156:157], v41 offset:4096
    ds_read_b64_tr_b16 v[158:159], v41 offset:6144
    s_waitcnt lgkmcnt(6)
    v_mfma_f32_32x32x16_bf16 v[64:79], v[136:139], v[128:131], v[64:79]
    v_mfma_f32_32x32x16_bf16 v[80:95], v[140:143], v[128:131], v[80:95]
    v_mfma_f32_32x32x16_bf16 v[96:111], v[136:139], v[132:135], v[96:111]
    v_mfma_f32_32x32x16_bf16 v[112:127], v[140:143], v[132:135], v[112:127]
    ds_read_b128 v[160:163], v42 offset:2048
    ds_read_b128 v[164:167], v42 offset:6144
    ds_read_b64_tr_b16 v[168:169], v40 offset:8192
    ds_read_b64_tr_b16 v[170:171], v40 offset:10240
    ds_read_b64_tr_b16 v[172:173], v41 offset:8192
    ds_read_b64_tr_b16 v[174:175], v41 offset:10240
    s_waitcnt lgkmcnt(6)
    v_mfma_f32_32x32x16_bf16 v[64:79], v[152:155], v[144:147], v[64:79]
    v_mfma_f32_32x32x16_bf16 v[80:95], v[156:159], v[144:147], v[80:95]
    v_mfma_f32_32x32x16_bf16 v[96:111], v[152:155], v[148:151], v[96:111]
    v_mfma_f32_32x32x16_bf16 v[112:127], v[156:159], v[148:151], v[112:127]
    ds_read_b128 v[176:179], v42 offset:3072
    ds_read_b128 v[180:183], v42 offset:7168
    ds_read_b64_tr_b16 v[184:185], v40 offset:12288
    ds_read_b64_tr_b16 v[186:187], v40 offset:14336
    ds_read_b64_tr_b16 v[188:189], v41 offset:12288
    ds_read_b64_tr_b16 v[190:191], v41 offset:14336
    s_waitcnt lgkmcnt(6)
    v_mfma_f32_32x32x16_bf16 v[64:79], v[168:171], v[160:163], v[64:79]
    v_mfma_f32_32x32x16_bf16 v[80:95], v[172:175], v[160:163], v[80:95]
    v_mfma_f32_32x32x16_bf16 v[96:111], v[168:171], v[164:167], v[96:111]
    v_mfma_f32_32x32x16_bf16 v[112:127], v[172:175], v[164:167], v[112:127]
    s_waitcnt lgkmcnt(0)
    v_mfma_f32_32x32x16_bf16 v[64:79], v[184:187], v[176:179], v[64:79]
    v_mfma_f32_32x32x16_bf16 v[80:95], v[188:191], v[176:179], v[80:95]
    v_mfma_f32_32x32x16_bf16 v[96:111], v[184:187], v[180:183], v[96:111]
    v_mfma_f32_32x32x16_bf16 v[112:127], v[188:191], v[180:183], v[112:127]
    s_waitcnt vmcnt(16)
    s_barrier
    s_add_u32 m0, s49, 65536
    s_mov_b32 s41, 786432
    buffer_load_dwordx4 v10, s[16:19], s41 offen lds
    s_add_u32 m0, s49, 66560
    s_mov_b32 s41, 786432
    buffer_load_dwordx4 v11, s[16:19], s41 offen lds
    s_add_u32 m0, s49, 67584
    s_mov_b32 s41, 786432
    buffer_load_dwordx4 v12, s[16:19], s41 offen lds
    s_add_u32 m0, s49, 68608
    s_mov_b32 s41, 786432
    buffer_load_dwordx4 v13, s[16:19], s41 offen lds
    s_add_u32 m0, s49, 81920
    s_mov_b32 s41, 24576
    buffer_load_dwordx4 v14, s[32:35], s41 offen lds
    s_add_u32 m0, s49, 82944
    s_mov_b32 s41, 25600
    buffer_load_dwordx4 v14, s[32:35], s41 offen lds
    s_add_u32 m0, s49, 83968
    s_mov_b32 s41, 26624
    buffer_load_dwordx4 v14, s[32:35], s41 offen lds
    s_add_u32 m0, s49, 84992
    s_mov_b32 s41, 27648
    buffer_load_dwordx4 v14, s[32:35], s41 offen lds
    v_add_u32 v40, 98304, v20
    v_add_u32 v41, 98304, v21
    v_add_u32 v42, 98304, v28
    ds_read_b128 v[128:131], v42 offset:0
    ds_read_b128 v[132:135], v42 offset:4096
    ds_read_b64_tr_b16 v[136:137], v40 offset:0
    ds_read_b64_tr_b16 v[138:139], v40 offset:2048
    ds_read_b64_tr_b16 v[140:141], v41 offset:0
    ds_read_b64_tr_b16 v[142:143], v41 offset:2048
    ds_read_b128 v[144:147], v42 offset:1024
    ds_read_b128 v[148:151], v42 offset:5120
    ds_read_b64_tr_b16 v[152:153], v40 offset:4096
    ds_read_b64_tr_b16 v[154:155], v40 offset:6144
    ds_read_b64_tr_b16 v[156:157], v41 offset:4096
    ds_read_b64_tr_b16 v[158:159], v41 offset:6144
    s_waitcnt lgkmcnt(6)
    v_mfma_f32_32x32x16_bf16 v[64:79], v[136:139], v[128:131], v[64:79]
    v_mfma_f32_32x32x16_bf16 v[80:95], v[140:143], v[128:131], v[80:95]
    v_mfma_f32_32x32x16_bf16 v[96:111], v[136:139], v[132:135], v[96:111]
    v_mfma_f32_32x32x16_bf16 v[112:127], v[140:143], v[132:135], v[112:127]
    ds_read_b128 v[160:163], v42 offset:2048
    ds_read_b128 v[164:167], v42 offset:6144
    ds_read_b64_tr_b16 v[168:169], v40 offset:8192
    ds_read_b64_tr_b16 v[170:171], v40 offset:10240
    ds_read_b64_tr_b16 v[172:173], v41 offset:8192
    ds_read_b64_tr_b16 v[174:175], v41 offset:10240
    s_waitcnt lgkmcnt(6)
    v_mfma_f32_32x32x16_bf16 v[64:79], v[152:155], v[144:147], v[64:79]
    v_mfma_f32_32x32x16_bf16 v[80:95], v[156:159], v[144:147], v[80:95]
    v_mfma_f32_32x32x16_bf16 v[96:111], v[152:155], v[148:151], v[96:111]
    v_mfma_f32_32x32x16_bf16 v[112:127], v[156:159], v[148:151], v[112:127]
    ds_read_b128 v[176:179], v42 offset:3072
    ds_read_b128 v[180:183], v42 offset:7168
    ds_read_b64_tr_b16 v[184:185], v40 offset:12288
    ds_read_b64_tr_b16 v[186:187], v40 offset:14336
    ds_read_b64_tr_b16 v[188:189], v41 offset:12288
    ds_read_b64_tr_b16 v[190:191], v41 offset:14336
    s_waitcnt lgkmcnt(6)
    v_mfma_f32_32x32x16_bf16 v[64:79], v[168:171], v[160:163], v[64:79]
    v_mfma_f32_32x32x16_bf16 v[80:95], v[172:175], v[160:163], v[80:95]
    v_mfma_f32_32x32x16_bf16 v[96:111], v[168:171], v[164:167], v[96:111]
    v_mfma_f32_32x32x16_bf16 v[112:127], v[172:175], v[164:167], v[112:127]
    s_waitcnt lgkmcnt(0)
    v_mfma_f32_32x32x16_bf16 v[64:79], v[184:187], v[176:179], v[64:79]
    v_mfma_f32_32x32x16_bf16 v[80:95], v[188:191], v[176:179], v[80:95]
    v_mfma_f32_32x32x16_bf16 v[96:111], v[184:187], v[180:183], v[96:111]
    v_mfma_f32_32x32x16_bf16 v[112:127], v[188:191], v[180:183], v[112:127]
    s_waitcnt vmcnt(16)
    s_barrier
    s_add_u32 m0, s49, 98304
    s_mov_b32 s41, 917504
    buffer_load_dwordx4 v10, s[16:19], s41 offen lds
    s_add_u32 m0, s49, 99328
    s_mov_b32 s41, 917504
    buffer_load_dwordx4 v11, s[16:19], s41 offen lds
    s_add_u32 m0, s49, 100352
    s_mov_b32 s41, 917504
    buffer_load_dwordx4 v12, s[16:19], s41 offen lds
    s_add_u32 m0, s49, 101376
    s_mov_b32 s41, 917504
    buffer_load_dwordx4 v13, s[16:19], s41 offen lds
    s_add_u32 m0, s49, 114688
    s_mov_b32 s41, 28672
    buffer_load_dwordx4 v14, s[32:35], s41 offen lds
    s_add_u32 m0, s49, 115712
    s_mov_b32 s41, 29696
    buffer_load_dwordx4 v14, s[32:35], s41 offen lds
    s_add_u32 m0, s49, 116736
    s_mov_b32 s41, 30720
    buffer_load_dwordx4 v14, s[32:35], s41 offen lds
    s_add_u32 m0, s49, 117760
    s_mov_b32 s41, 31744
    buffer_load_dwordx4 v14, s[32:35], s41 offen lds
    v_add_u32 v40, 0, v20
    v_add_u32 v41, 0, v21
    v_add_u32 v42, 0, v28
    ds_read_b128 v[128:131], v42 offset:0
    ds_read_b128 v[132:135], v42 offset:4096
    ds_read_b64_tr_b16 v[136:137], v40 offset:0
    ds_read_b64_tr_b16 v[138:139], v40 offset:2048
    ds_read_b64_tr_b16 v[140:141], v41 offset:0
    ds_read_b64_tr_b16 v[142:143], v41 offset:2048
    ds_read_b128 v[144:147], v42 offset:1024
    ds_read_b128 v[148:151], v42 offset:5120
    ds_read_b64_tr_b16 v[152:153], v40 offset:4096
    ds_read_b64_tr_b16 v[154:155], v40 offset:6144
    ds_read_b64_tr_b16 v[156:157], v41 offset:4096
    ds_read_b64_tr_b16 v[158:159], v41 offset:6144
    s_waitcnt lgkmcnt(6)
    v_mfma_f32_32x32x16_bf16 v[64:79], v[136:139], v[128:131], v[64:79]
    v_mfma_f32_32x32x16_bf16 v[80:95], v[140:143], v[128:131], v[80:95]
    v_mfma_f32_32x32x16_bf16 v[96:111], v[136:139], v[132:135], v[96:111]
    v_mfma_f32_32x32x16_bf16 v[112:127], v[140:143], v[132:135], v[112:127]
    ds_read_b128 v[160:163], v42 offset:2048
    ds_read_b128 v[164:167], v42 offset:6144
    ds_read_b64_tr_b16 v[168:169], v40 offset:8192
    ds_read_b64_tr_b16 v[170:171], v40 offset:10240
    ds_read_b64_tr_b16 v[172:173], v41 offset:8192
    ds_read_b64_tr_b16 v[174:175], v41 offset:10240
    s_waitcnt lgkmcnt(6)
    v_mfma_f32_32x32x16_bf16 v[64:79], v[152:155], v[144:147], v[64:79]
    v_mfma_f32_32x32x16_bf16 v[80:95], v[156:159], v[144:147], v[80:95]
    v_mfma_f32_32x32x16_bf16 v[96:111], v[152:155], v[148:151], v[96:111]
    v_mfma_f32_32x32x16_bf16 v[112:127], v[156:159], v[148:151], v[112:127]
    ds_read_b128 v[176:179], v42 offset:3072
    ds_read_b128 v[180:183], v42 offset:7168
    ds_read_b64_tr_b16 v[184:185], v40 offset:12288
    ds_read_b64_tr_b16 v[186:187], v40 offset:14336
    ds_read_b64_tr_b16 v[188:189], v41 offset:12288
    ds_read_b64_tr_b16 v[190:191], v41 offset:14336
    s_waitcnt lgkmcnt(6)
    v_mfma_f32_32x32x16_bf16 v[64:79], v[168:171], v[160:163], v[64:79]
    v_mfma_f32_32x32x16_bf16 v[80:95], v[172:175], v[160:163], v[80:95]
    v_mfma_f32_32x32x16_bf16 v[96:111], v[168:171], v[164:167], v[96:111]
    v_mfma_f32_32x32x16_bf16 v[112:127], v[172:175], v[164:167], v[112:127]
    s_waitcnt lgkmcnt(0)
    v_mfma_f32_32x32x16_bf16 v[64:79], v[184:187], v[176:179], v[64:79]
    v_mfma_f32_32x32x16_bf16 v[80:95], v[188:191], v[176:179], v[80:95]
    v_mfma_f32_32x32x16_bf16 v[96:111], v[184:187], v[180:183], v[96:111]
    v_mfma_f32_32x32x16_bf16 v[112:127], v[188:191], v[180:183], v[112:127]
    s_waitcnt vmcnt(16)
    s_barrier
    v_add_u32 v40, 32768, v20
    v_add_u32 v41, 32768, v21
    v_add_u32 v42, 32768, v28
    ds_read_b128 v[128:131], v42 offset:0
    ds_read_b128 v[132:135], v42 offset:4096
    ds_read_b64_tr_b16 v[136:137], v40 offset:0
    ds_read_b64_tr_b16 v[138:139], v40 offset:2048
    ds_read_b64_tr_b16 v[140:141], v41 offset:0
    ds_read_b64_tr_b16 v[142:143], v41 offset:2048
    ds_read_b128 v[144:147], v42 offset:1024
    ds_read_b128 v[148:151], v42 offset:5120
    ds_read_b64_tr_b16 v[152:153], v40 offset:4096
    ds_read_b64_tr_b16 v[154:155], v40 offset:6144
    ds_read_b64_tr_b16 v[156:157], v41 offset:4096
    ds_read_b64_tr_b16 v[158:159], v41 offset:6144
    s_waitcnt lgkmcnt(6)
    v_mfma_f32_32x32x16_bf16 v[64:79], v[136:139], v[128:131], v[64:79]
    v_mfma_f32_32x32x16_bf16 v[80:95], v[140:143], v[128:131], v[80:95]
    v_mfma_f32_32x32x16_bf16 v[96:111], v[136:139], v[132:135], v[96:111]
    v_mfma_f32_32x32x16_bf16 v[112:127], v[140:143], v[132:135], v[112:127]
    ds_read_b128 v[160:163], v42 offset:2048
    ds_read_b128 v[164:167], v42 offset:6144
    ds_read_b64_tr_b16 v[168:169], v40 offset:8192
    ds_read_b64_tr_b16 v[170:171], v40 offset:10240
    ds_read_b64_tr_b16 v[172:173], v41 offset:8192
    ds_read_b64_tr_b16 v[174:175], v41 offset:10240
    s_waitcnt lgkmcnt(6)
    v_mfma_f32_32x32x16_bf16 v[64:79], v[152:155], v[144:147], v[64:79]
    v_mfma_f32_32x32x16_bf16 v[80:95], v[156:159], v[144:147], v[80:95]
    v_mfma_f32_32x32x16_bf16 v[96:111], v[152:155], v[148:151], v[96:111]
    v_mfma_f32_32x32x16_bf16 v[112:127], v[156:159], v[148:151], v[112:127]
    ds_read_b128 v[176:179], v42 offset:3072
    ds_read_b128 v[180:183], v42 offset:7168
    ds_read_b64_tr_b16 v[184:185], v40 offset:12288
    ds_read_b64_tr_b16 v[186:187], v40 offset:14336
    ds_read_b64_tr_b16 v[188:189], v41 offset:12288
    ds_read_b64_tr_b16 v[190:191], v41 offset:14336
    s_waitcnt lgkmcnt(6)
    v_mfma_f32_32x32x16_bf16 v[64:79], v[168:171], v[160:163], v[64:79]
    v_mfma_f32_32x32x16_bf16 v[80:95], v[172:175], v[160:163], v[80:95]
    v_mfma_f32_32x32x16_bf16 v[96:111], v[168:171], v[164:167], v[96:111]
    v_mfma_f32_32x32x16_bf16 v[112:127], v[172:175], v[164:167], v[112:127]
    s_waitcnt lgkmcnt(0)
    v_mfma_f32_32x32x16_bf16 v[64:79], v[184:187], v[176:179], v[64:79]
    v_mfma_f32_32x32x16_bf16 v[80:95], v[188:191], v[176:179], v[80:95]
    v_mfma_f32_32x32x16_bf16 v[96:111], v[184:187], v[180:183], v[96:111]
    v_mfma_f32_32x32x16_bf16 v[112:127], v[188:191], v[180:183], v[112:127]
    s_waitcnt vmcnt(8)
    s_barrier
    v_add_u32 v40, 65536, v20
    v_add_u32 v41, 65536, v21
    v_add_u32 v42, 65536, v28
    ds_read_b128 v[128:131], v42 offset:0
    ds_read_b128 v[132:135], v42 offset:4096
    ds_read_b64_tr_b16 v[136:137], v40 offset:0
    ds_read_b64_tr_b16 v[138:139], v40 offset:2048
    ds_read_b64_tr_b16 v[140:141], v41 offset:0
    ds_read_b64_tr_b16 v[142:143], v41 offset:2048
    ds_read_b128 v[144:147], v42 offset:1024
    ds_read_b128 v[148:151], v42 offset:5120
    ds_read_b64_tr_b16 v[152:153], v40 offset:4096
    ds_read_b64_tr_b16 v[154:155], v40 offset:6144
    ds_read_b64_tr_b16 v[156:157], v41 offset:4096
    ds_read_b64_tr_b16 v[158:159], v41 offset:6144
    s_waitcnt lgkmcnt(6)
    v_mfma_f32_32x32x16_bf16 v[64:79], v[136:139], v[128:131], v[64:79]
    v_mfma_f32_32x32x16_bf16 v[80:95], v[140:143], v[128:131], v[80:95]
    v_mfma_f32_32x32x16_bf16 v[96:111], v[136:139], v[132:135], v[96:111]
    v_mfma_f32_32x32x16_bf16 v[112:127], v[140:143], v[132:135], v[112:127]
    ds_read_b128 v[160:163], v42 offset:2048
    ds_read_b128 v[164:167], v42 offset:6144
    ds_read_b64_tr_b16 v[168:169], v40 offset:8192
    ds_read_b64_tr_b16 v[170:171], v40 offset:10240
    ds_read_b64_tr_b16 v[172:173], v41 offset:8192
    ds_read_b64_tr_b16 v[174:175], v41 offset:10240
    s_waitcnt lgkmcnt(6)
    v_mfma_f32_32x32x16_bf16 v[64:79], v[152:155], v[144:147], v[64:79]
    v_mfma_f32_32x32x16_bf16 v[80:95], v[156:159], v[144:147], v[80:95]
    v_mfma_f32_32x32x16_bf16 v[96:111], v[152:155], v[148:151], v[96:111]
    v_mfma_f32_32x32x16_bf16 v[112:127], v[156:159], v[148:151], v[112:127]
    ds_read_b128 v[176:179], v42 offset:3072
    ds_read_b128 v[180:183], v42 offset:7168
    ds_read_b64_tr_b16 v[184:185], v40 offset:12288
    ds_read_b64_tr_b16 v[186:187], v40 offset:14336
    ds_read_b64_tr_b16 v[188:189], v41 offset:12288
    ds_read_b64_tr_b16 v[190:191], v41 offset:14336
    s_waitcnt lgkmcnt(6)
    v_mfma_f32_32x32x16_bf16 v[64:79], v[168:171], v[160:163], v[64:79]
    v_mfma_f32_32x32x16_bf16 v[80:95], v[172:175], v[160:163], v[80:95]
    v_mfma_f32_32x32x16_bf16 v[96:111], v[168:171], v[164:167], v[96:111]
    v_mfma_f32_32x32x16_bf16 v[112:127], v[172:175], v[164:167], v[112:127]
    s_waitcnt lgkmcnt(0)
    v_mfma_f32_32x32x16_bf16 v[64:79], v[184:187], v[176:179], v[64:79]
    v_mfma_f32_32x32x16_bf16 v[80:95], v[188:191], v[176:179], v[80:95]
    v_mfma_f32_32x32x16_bf16 v[96:111], v[184:187], v[180:183], v[96:111]
    v_mfma_f32_32x32x16_bf16 v[112:127], v[188:191], v[180:183], v[112:127]
    s_waitcnt vmcnt(0)
    s_barrier
    v_add_u32 v40, 98304, v20
    v_add_u32 v41, 98304, v21
    v_add_u32 v42, 98304, v28
    ds_read_b128 v[128:131], v42 offset:0
    ds_read_b128 v[132:135], v42 offset:4096
    ds_read_b64_tr_b16 v[136:137], v40 offset:0
    ds_read_b64_tr_b16 v[138:139], v40 offset:2048
    ds_read_b64_tr_b16 v[140:141], v41 offset:0
    ds_read_b64_tr_b16 v[142:143], v41 offset:2048
    ds_read_b128 v[144:147], v42 offset:1024
    ds_read_b128 v[148:151], v42 offset:5120
    ds_read_b64_tr_b16 v[152:153], v40 offset:4096
    ds_read_b64_tr_b16 v[154:155], v40 offset:6144
    ds_read_b64_tr_b16 v[156:157], v41 offset:4096
    ds_read_b64_tr_b16 v[158:159], v41 offset:6144
    s_waitcnt lgkmcnt(6)
    v_mfma_f32_32x32x16_bf16 v[64:79], v[136:139], v[128:131], v[64:79]
    v_mfma_f32_32x32x16_bf16 v[80:95], v[140:143], v[128:131], v[80:95]
    v_mfma_f32_32x32x16_bf16 v[96:111], v[136:139], v[132:135], v[96:111]
    v_mfma_f32_32x32x16_bf16 v[112:127], v[140:143], v[132:135], v[112:127]
    ds_read_b128 v[160:163], v42 offset:2048
    ds_read_b128 v[164:167], v42 offset:6144
    ds_read_b64_tr_b16 v[168:169], v40 offset:8192
    ds_read_b64_tr_b16 v[170:171], v40 offset:10240
    ds_read_b64_tr_b16 v[172:173], v41 offset:8192
    ds_read_b64_tr_b16 v[174:175], v41 offset:10240
    s_waitcnt lgkmcnt(6)
    v_mfma_f32_32x32x16_bf16 v[64:79], v[152:155], v[144:147], v[64:79]
    v_mfma_f32_32x32x16_bf16 v[80:95], v[156:159], v[144:147], v[80:95]
    v_mfma_f32_32x32x16_bf16 v[96:111], v[152:155], v[148:151], v[96:111]
    v_mfma_f32_32x32x16_bf16 v[112:127], v[156:159], v[148:151], v[112:127]
    ds_read_b128 v[176:179], v42 offset:3072
    ds_read_b128 v[180:183], v42 offset:7168
    ds_read_b64_tr_b16 v[184:185], v40 offset:12288
    ds_read_b64_tr_b16 v[186:187], v40 offset:14336
    ds_read_b64_tr_b16 v[188:189], v41 offset:12288
    ds_read_b64_tr_b16 v[190:191], v41 offset:14336
    s_waitcnt lgkmcnt(6)
    v_mfma_f32_32x32x16_bf16 v[64:79], v[168:171], v[160:163], v[64:79]
    v_mfma_f32_32x32x16_bf16 v[80:95], v[172:175], v[160:163], v[80:95]
    v_mfma_f32_32x32x16_bf16 v[96:111], v[168:171], v[164:167], v[96:111]
    v_mfma_f32_32x32x16_bf16 v[112:127], v[172:175], v[164:167], v[112:127]
    s_waitcnt lgkmcnt(0)
    v_mfma_f32_32x32x16_bf16 v[64:79], v[184:187], v[176:179], v[64:79]
    v_mfma_f32_32x32x16_bf16 v[80:95], v[188:191], v[176:179], v[80:95]
    v_mfma_f32_32x32x16_bf16 v[96:111], v[184:187], v[180:183], v[96:111]
    v_mfma_f32_32x32x16_bf16 v[112:127], v[188:191], v[180:183], v[112:127]
    s_nop 15
    s_nop 7
    s_lshl_b32 s45, s39, 2
    s_add_u32 s45, s45, s38
    s_lshl_b32 s45, s45, 3
    s_add_u32 s45, s45, s37
    s_lshl_b32 s45, s45, 2
    s_add_u32 s45, s45, s36
    s_lshl_b32 s45, s45, 14
    s_add_u32 s45, s45, 0x400000
    buffer_store_dwordx4 v[64:67], v5, s[32:35], s45 offen offset:0
    buffer_store_dwordx4 v[68:71], v5, s[32:35], s45 offen offset:1024
    buffer_store_dwordx4 v[72:75], v5, s[32:35], s45 offen offset:2048
    buffer_store_dwordx4 v[76:79], v5, s[32:35], s45 offen offset:3072
    s_add_u32 s45, s45, 4096
    buffer_store_dwordx4 v[80:83], v5, s[32:35], s45 offen offset:0
    buffer_store_dwordx4 v[84:87], v5, s[32:35], s45 offen offset:1024
    buffer_store_dwordx4 v[88:91], v5, s[32:35], s45 offen offset:2048
    buffer_store_dwordx4 v[92:95], v5, s[32:35], s45 offen offset:3072
    s_add_u32 s45, s45, 4096
    buffer_store_dwordx4 v[96:99], v5, s[32:35], s45 offen offset:0
    buffer_store_dwordx4 v[100:103], v5, s[32:35], s45 offen offset:1024
    buffer_store_dwordx4 v[104:107], v5, s[32:35], s45 offen offset:2048
    buffer_store_dwordx4 v[108:111], v5, s[32:35], s45 offen offset:3072
    s_add_u32 s45, s45, 4096
    buffer_store_dwordx4 v[112:115], v5, s[32:35], s45 offen offset:0
    buffer_store_dwordx4 v[116:119], v5, s[32:35], s45 offen offset:1024
    buffer_store_dwordx4 v[120:123], v5, s[32:35], s45 offen offset:2048
    buffer_store_dwordx4 v[124:127], v5, s[32:35], s45 offen offset:3072
k2_end:
    s_endpgm
.globl k3_kernel
.p2align 8
.type k3_kernel,@function
k3_kernel:
    s_cmp_ge_u32 s2, 512
    s_cbranch_scc1 k3_end
    s_load_dwordx2 s[4:5], s[0:1], 40
    s_load_dwordx2 s[12:13], s[0:1], 56
    s_lshl_b32 s3, s2, 8
    v_add_u32 v1, s3, v0
    v_lshlrev_b32 v2, 4, v1
    s_waitcnt lgkmcnt(0)
    s_mov_b32 s16, s4
    s_mov_b32 s17, s5
    s_mov_b32 s18, 1048576
    s_mov_b32 s19, 0x00020000
    s_mov_b32 s32, s12
    s_mov_b32 s33, s13
    s_mov_b32 s34, 20971520
    s_mov_b32 s35, 0x00020000
    s_mov_b32 s20, 4194304
    buffer_load_dwordx4 v[8:11], v2, s[32:35], s20 offen
    s_mov_b32 s20, 6291456
    buffer_load_dwordx4 v[12:15], v2, s[32:35], s20 offen
    s_mov_b32 s20, 8388608
    buffer_load_dwordx4 v[16:19], v2, s[32:35], s20 offen
    s_mov_b32 s20, 10485760
    buffer_load_dwordx4 v[20:23], v2, s[32:35], s20 offen
    s_mov_b32 s20, 12582912
    buffer_load_dwordx4 v[24:27], v2, s[32:35], s20 offen
    s_mov_b32 s20, 14680064
    buffer_load_dwordx4 v[28:31], v2, s[32:35], s20 offen
    s_mov_b32 s20, 16777216
    buffer_load_dwordx4 v[32:35], v2, s[32:35], s20 offen
    s_mov_b32 s20, 18874368
    buffer_load_dwordx4 v[36:39], v2, s[32:35], s20 offen
    v_and_b32 v3, 31, v1
    v_bfe_u32 v4, v1, 9, 1
    v_lshl_add_u32 v3, v4, 5, v3
    v_bfe_u32 v4, v1, 11, 1
    v_lshl_add_u32 v3, v4, 6, v3
    v_bfe_u32 v4, v1, 15, 2
    v_lshl_add_u32 v3, v4, 7, v3
    v_bfe_u32 v5, v1, 5, 1
    v_lshlrev_b32 v5, 2, v5
    v_bfe_u32 v4, v1, 6, 2
    v_lshl_add_u32 v5, v4, 3, v5
    v_bfe_u32 v4, v1, 8, 1
    v_lshl_add_u32 v5, v4, 5, v5
    v_bfe_u32 v4, v1, 10, 1
    v_lshl_add_u32 v5, v4, 6, v5
    v_bfe_u32 v4, v1, 12, 3
    v_lshl_add_u32 v5, v4, 7, v5
    v_lshlrev_b32 v3, 11, v3
    v_lshl_add_u32 v3, v5, 1, v3
    s_waitcnt vmcnt(0)
    v_add_f32 v8, v8, v12
    v_add_f32 v9, v9, v13
    v_add_f32 v10, v10, v14
    v_add_f32 v11, v11, v15
    v_add_f32 v8, v8, v16
    v_add_f32 v9, v9, v17
    v_add_f32 v10, v10, v18
    v_add_f32 v11, v11, v19
    v_add_f32 v8, v8, v20
    v_add_f32 v9, v9, v21
    v_add_f32 v10, v10, v22
    v_add_f32 v11, v11, v23
    v_add_f32 v8, v8, v24
    v_add_f32 v9, v9, v25
    v_add_f32 v10, v10, v26
    v_add_f32 v11, v11, v27
    v_add_f32 v8, v8, v28
    v_add_f32 v9, v9, v29
    v_add_f32 v10, v10, v30
    v_add_f32 v11, v11, v31
    v_add_f32 v8, v8, v32
    v_add_f32 v9, v9, v33
    v_add_f32 v10, v10, v34
    v_add_f32 v11, v11, v35
    v_add_f32 v8, v8, v36
    v_add_f32 v9, v9, v37
    v_add_f32 v10, v10, v38
    v_add_f32 v11, v11, v39
    v_cvt_pk_bf16_f32 v6, v8, v9
    v_cvt_pk_bf16_f32 v7, v10, v11
    s_nop 1
    buffer_store_dwordx2 v[6:7], v3, s[16:19], 0 offen
k3_end:
    s_endpgm
.section .rodata,"a"
.p2align 6
.amdhsa_kernel k1_kernel
  .amdhsa_next_free_vgpr 256
  .amdhsa_next_free_sgpr 102
  .amdhsa_accum_offset 256
  .amdhsa_group_segment_fixed_size 0
  .amdhsa_kernarg_size 64
  .amdhsa_user_sgpr_count 2
  .amdhsa_user_sgpr_kernarg_segment_ptr 1
  .amdhsa_system_sgpr_workgroup_id_x 1
.end_amdhsa_kernel
.p2align 6
.amdhsa_kernel k2_kernel
  .amdhsa_next_free_vgpr 256
  .amdhsa_next_free_sgpr 102
  .amdhsa_accum_offset 256
  .amdhsa_group_segment_fixed_size 0
  .amdhsa_kernarg_size 64
  .amdhsa_user_sgpr_count 2
  .amdhsa_user_sgpr_kernarg_segment_ptr 1
  .amdhsa_system_sgpr_workgroup_id_x 1
.end_amdhsa_kernel
.p2align 6
.amdhsa_kernel k3_kernel
  .amdhsa_next_free_vgpr 256
  .amdhsa_next_free_sgpr 102
  .amdhsa_accum_offset 256
  .amdhsa_group_segment_fixed_size 0
  .amdhsa_kernarg_size 64
  .amdhsa_user_sgpr_count 2
  .amdhsa_user_sgpr_kernarg_segment_ptr 1
  .amdhsa_system_sgpr_workgroup_id_x 1
.end_amdhsa_kernel
```
